```python
import torch

def _softmax(x, axis=-1):
    return torch.softmax(x, dim=axis)
def _gelu(x):
    return torch.nn.functional.gelu(x, approximate="tanh")
def _silu(x):
    return torch.nn.functional.silu(x)
def _sigmoid(x):
    return torch.sigmoid(x)
def _layernorm(x, axis=-1, eps=1e-5):
    m = x.mean(dim=axis, keepdim=True)
    v = x.var(dim=axis, keepdim=True, unbiased=False)
    return (x - m) / torch.sqrt(v + eps)
def _scatter_add(tgt, idx, src, axis=0):
    return tgt.clone().index_add_(axis, idx, src)
def _segment_sum(src, seg, n):
    out = torch.zeros((n,) + src.shape[1:], dtype=src.dtype)
    return out.index_add_(0, seg, src)
def _pad(x, pw):
    flat = tuple(v for pair in reversed(pw) for v in pair)
    return torch.nn.functional.pad(x, flat)

kernel_name = 'recurrent_scan__gqa_block_cached__glu_gated_bilinear__decode'

def setup_inputs():

    _w = (lambda a: (lambda t: t.to(torch.bfloat16) if t.is_floating_point() else t)(torch.as_tensor(a)))
    def _A_setup():
        B, Sq, D = 2, 1, 640
        Hq, Hkv, Sk, Dh = 32, 32, 4096, 192
        assert Hq % Hkv == 0, (Hq, Hkv)
        return {
            "x": _w((lambda *s: torch.randn(*s, dtype=torch.bfloat16) * 0.2)(B, Sq, D)),
            "k_cache": _w((lambda *s: torch.randn(*s, dtype=torch.bfloat16) * 1.6)(B, Hkv, Sk, Dh)),
            "v_cache": _w((lambda *s: torch.randn(*s, dtype=torch.bfloat16) * 1.6)(B, Hkv, Sk, Dh)),
            "wq": _w((lambda *s: torch.randn(*s, dtype=torch.bfloat16) * 1.6)(D, Hq * Dh) * (D ** -0.5)),
            "wo": _w((lambda *s: torch.randn(*s, dtype=torch.bfloat16) * 1.6)(Hq * Dh, D) * ((Hq * Dh) ** -0.5)),
        }
    _A_in = _A_setup()

    def _B_setup():
        B, S, D, F = 2, 1, 640, 1536
        return {
            "x": _w((lambda *s: torch.randn(*s, dtype=torch.bfloat16) * 0.2)(B, S, D)),
            "w_gate": _w((lambda *s: torch.randn(*s, dtype=torch.bfloat16) * 0.8)(D, F) * (D ** -0.5)),
            "w_up": _w((lambda *s: torch.randn(*s, dtype=torch.bfloat16) * 0.8)(D, F) * (D ** -0.5)),
            "w_down": _w((lambda *s: torch.randn(*s, dtype=torch.bfloat16) * 0.8)(F, D) * (F ** -0.5)),
        }
    _B_in = _B_setup()

    return {
        "A_x": _A_in["x"],
        "A_k_cache": _A_in["k_cache"],
        "A_v_cache": _A_in["v_cache"],
        "A_wq": _A_in["wq"],
        "A_wo": _A_in["wo"],
        "B_x": _B_in["x"],
        "B_w_gate": _B_in["w_gate"],
        "B_w_up": _B_in["w_up"],
        "B_w_down": _B_in["w_down"],
    }

def reference(A_x, A_k_cache, A_v_cache, A_wq, A_wo, B_x, B_w_gate, B_w_up, B_w_down):
    def _A_ref(x, k_cache, v_cache, wq, wo):
        B, Sq, D = x.shape
        Hq, Dh = 32, 192
        Hkv = k_cache.shape[1]
        rep = Hq // Hkv
        q = (lambda x, *d: x.permute(*d))((x @ wq).reshape(B, Sq, Hq, Dh), 0, 2, 1, 3)
        k = (lambda x, n, axis: torch.repeat_interleave(x, n, dim=axis))(k_cache, rep, axis=1)
        v = (lambda x, n, axis: torch.repeat_interleave(x, n, dim=axis))(v_cache, rep, axis=1)
        scores = torch.einsum("bhqd,bhkd->bhqk", q, k) * (Dh ** -0.5)
        p = _softmax(scores, axis=-1)
        o = torch.einsum("bhqk,bhkd->bhqd", p, v)
        return (lambda x, *d: x.permute(*d))(o, 0, 2, 1, 3).reshape(B, Sq, Hq * Dh) @ wo

    def _B_ref(x, w_gate, w_up, w_down):
        g = torch.einsum("bsd,df->bsf", x, w_gate)
        u = torch.einsum("bsd,df->bsf", x, w_up)
        h = g * u
        return torch.einsum("bsf,fd->bsd", h, w_down)

    x = A_x
    xn = _layernorm(x, axis=-1)
    s = _A_ref(xn, A_k_cache, A_v_cache, A_wq, A_wo)
    g = _silu(_B_ref(xn, B_w_gate, B_w_up, B_w_down))
    return x + s * g
```

```asm
; @launch grid=(256,1,1) block=(512,1,1) lds=20992
.amdgcn_target "amdgcn-amd-amdhsa--gfx950"
.text
.globl recurrent_scan__gqa_block_cached__glu_gated_bilinear__decode_kernel
.p2align 8
.type recurrent_scan__gqa_block_cached__glu_gated_bilinear__decode_kernel,@function
recurrent_scan__gqa_block_cached__glu_gated_bilinear__decode_kernel:
    s_load_dwordx16 s[16:31], s[0:1], 0
    s_load_dwordx8 s[32:39], s[0:1], 64
    s_cmp_ge_u32 s2, 256
    s_cbranch_scc1 L_end
    v_lshrrev_b32 v1, 6, v0
    s_lshr_b32 s4, s2, 3
    v_readfirstlane_b32 s3, v1
    v_and_b32 v1, 63, v0
    s_and_b32 s5, s2, 7
    s_add_u32 s6, s4, s5
    s_and_b32 s6, s6, 7
    s_cmp_eq_u32 s3, 7
    s_cbranch_scc0 L_nopf
    s_getpc_b64 s[96:97]
L_pc:
    s_sub_u32 s96, s96, L_pc-recurrent_scan__gqa_block_cached__glu_gated_bilinear__decode_kernel
    s_subb_u32 s97, s97, 0
    v_lshlrev_b32 v2, 7, v1
    v_min_u32 v3, L_codeend-recurrent_scan__gqa_block_cached__glu_gated_bilinear__decode_kernel-4, v2
    global_load_dword v6, v3, s[96:97]
    v_add_u32 v2, 8192, v2
    v_min_u32 v4, L_codeend-recurrent_scan__gqa_block_cached__glu_gated_bilinear__decode_kernel-4, v2
    global_load_dword v7, v4, s[96:97]
    v_add_u32 v2, 8192, v2
    v_min_u32 v5, L_codeend-recurrent_scan__gqa_block_cached__glu_gated_bilinear__decode_kernel-4, v2
    global_load_dword v8, v5, s[96:97]
L_nopf:
    s_cmp_ge_u32 s3, 4
    s_cbranch_scc1 L_nonstream
    s_mov_b32 s7, s3
    v_lshrrev_b32 v2, 5, v1
    v_bfe_u32 v3, v1, 2, 2
    v_lshl_add_u32 v2, v2, 2, v3
    v_mul_u32_u24 v2, 384, v2
    v_bfe_u32 v3, v1, 4, 1
    v_lshl_add_u32 v2, v3, 6, v2
    v_and_b32 v3, 3, v1
    v_lshl_add_u32 v2, v3, 4, v2
    v_lshrrev_b32 v3, 3, v1
    v_mul_u32_u24 v3, 768, v3
    v_and_b32 v4, 7, v1
    v_lshl_add_u32 v3, v4, 4, v3
    s_mul_i32 s8, s4, 1572864
    s_lshl_b32 s57, s5, 2
    s_add_u32 s57, s57, s7
    s_mul_i32 s74, s4, 8
    s_add_u32 s14, s57, s74
    s_and_b32 s9, s14, 255
    s_mul_i32 s12, s9, 6144
    s_sub_u32 s42, 100663296, s8
    s_mov_b32 s43, 0x20000
    s_sub_u32 s46, 100663296, s8
    s_mov_b32 s47, 0x20000
    s_waitcnt lgkmcnt(0)
    s_add_u32 s40, s18, s8
    s_addc_u32 s41, s19, 0
    s_and_b32 s41, s41, 0xffff
    s_add_u32 s44, s20, s8
    s_addc_u32 s45, s21, 0
    s_and_b32 s45, s45, 0xffff
    buffer_load_dwordx4 v[64:67], v2, s[40:43], s12 offen offset:0 nt
    buffer_load_dwordx4 v[68:71], v2, s[40:43], s12 offen offset:128 nt
    buffer_load_dwordx4 v[72:75], v2, s[40:43], s12 offen offset:256 nt
    buffer_load_dwordx4 v[76:79], v2, s[40:43], s12 offen offset:3072 nt
    buffer_load_dwordx4 v[80:83], v2, s[40:43], s12 offen offset:3200 nt
    buffer_load_dwordx4 v[84:87], v2, s[40:43], s12 offen offset:3328 nt
    buffer_load_dwordx4 v[88:91], v3, s[44:47], s12 offen offset:0 nt
    s_mov_b32 s48, s38
    s_and_b32 s49, s39, 0xffff
    s_mov_b32 s50, 2097152
    s_mov_b32 s51, 0x20000
    s_mul_i32 s76, s4, 4096
    s_add_u32 s76, s76, 1835008
    s_add_u32 s98, s38, s76
    s_addc_u32 s99, s39, 0
    s_mov_b32 s13, 0
    v_and_b32 v29, 1, v1
    v_lshlrev_b32 v29, 4, v29
    v_mov_b32 v30, 0xffff
    v_lshlrev_b32 v29, v29, v30
    v_bfe_u32 v30, v1, 1, 2
    v_cmp_eq_u32 vcc, 0, v30
    s_nop 1
    v_cndmask_b32 v4, 0, v29, vcc
    v_cmp_eq_u32 vcc, 1, v30
    s_nop 1
    v_cndmask_b32 v5, 0, v29, vcc
    v_cmp_eq_u32 vcc, 2, v30
    s_nop 1
    v_cndmask_b32 v6, 0, v29, vcc
    v_cmp_eq_u32 vcc, 3, v30
    s_nop 1
    v_cndmask_b32 v7, 0, v29, vcc
    v_lshrrev_b32 v29, 5, v1
    v_bfe_u32 v30, v1, 3, 1
    v_cmp_eq_u32 s[72:73], v29, v30
    v_mov_b32 v8, 0
    v_mov_b32 v9, 0
    v_mov_b32 v10, 0
    v_mov_b32 v11, 0
    v_mov_b32 v12, 0
    v_mov_b32 v13, 0
    v_mov_b32 v14, 0
    v_mov_b32 v15, 0
    v_mov_b32 v16, 0
    v_mov_b32 v17, 0
    v_mov_b32 v18, 0
    v_mov_b32 v19, 0
    v_mov_b32 v26, 0xff7fffff
    v_mov_b32 v27, 0
    s_barrier
    s_waitcnt vmcnt(6)
    buffer_load_dwordx4 v[92:95], v3, s[44:47], s12 offen offset:128 nt
    s_waitcnt vmcnt(6)
    buffer_load_dwordx4 v[96:99], v3, s[44:47], s12 offen offset:256 nt
    s_waitcnt vmcnt(6)
    buffer_load_dwordx4 v[100:103], v3, s[44:47], s12 offen offset:384 nt
    s_waitcnt vmcnt(6)
    buffer_load_dwordx4 v[104:107], v3, s[44:47], s12 offen offset:512 nt
    s_waitcnt vmcnt(6)
    buffer_load_dwordx4 v[108:111], v3, s[44:47], s12 offen offset:640 nt
    s_add_u32 s14, s14, 32
    s_and_b32 s12, s14, 255
    s_mul_i32 s12, s12, 6144
    s_waitcnt vmcnt(6)
    buffer_load_dwordx4 v[112:115], v2, s[40:43], s12 offen offset:0 nt
    s_waitcnt vmcnt(6)
    buffer_load_dwordx4 v[116:119], v2, s[40:43], s12 offen offset:128 nt
    s_waitcnt vmcnt(6)
    buffer_load_dwordx4 v[120:123], v2, s[40:43], s12 offen offset:256 nt
    s_waitcnt vmcnt(6)
    buffer_load_dwordx4 v[124:127], v2, s[40:43], s12 offen offset:3072 nt
    s_waitcnt vmcnt(6)
    buffer_load_dwordx4 v[128:131], v2, s[40:43], s12 offen offset:3200 nt
    s_waitcnt vmcnt(6)
    buffer_load_dwordx4 v[132:135], v2, s[40:43], s12 offen offset:3328 nt
    s_waitcnt vmcnt(6)
    buffer_load_dwordx4 v[136:139], v3, s[44:47], s12 offen offset:0 nt
    s_waitcnt vmcnt(6)
    buffer_load_dwordx4 v[140:143], v3, s[44:47], s12 offen offset:128 nt
    s_waitcnt vmcnt(6)
    buffer_load_dwordx4 v[144:147], v3, s[44:47], s12 offen offset:256 nt
    s_waitcnt vmcnt(6)
    buffer_load_dwordx4 v[148:151], v3, s[44:47], s12 offen offset:384 nt
    s_waitcnt vmcnt(6)
    buffer_load_dwordx4 v[152:155], v3, s[44:47], s12 offen offset:512 nt
    s_waitcnt vmcnt(6)
    buffer_load_dwordx4 v[156:159], v3, s[44:47], s12 offen offset:640 nt
    s_add_u32 s14, s14, 32
    s_and_b32 s12, s14, 255
    s_mul_i32 s12, s12, 6144
    s_waitcnt vmcnt(6)
    buffer_load_dwordx4 v[160:163], v2, s[40:43], s12 offen offset:0 nt
    s_waitcnt vmcnt(6)
    buffer_load_dwordx4 v[164:167], v2, s[40:43], s12 offen offset:128 nt
    s_waitcnt vmcnt(6)
    buffer_load_dwordx4 v[168:171], v2, s[40:43], s12 offen offset:256 nt
    s_waitcnt vmcnt(6)
    buffer_load_dwordx4 v[172:175], v2, s[40:43], s12 offen offset:3072 nt
    s_waitcnt vmcnt(6)
    buffer_load_dwordx4 v[176:179], v2, s[40:43], s12 offen offset:3200 nt
    s_waitcnt vmcnt(6)
    buffer_load_dwordx4 v[180:183], v2, s[40:43], s12 offen offset:3328 nt
    s_waitcnt vmcnt(6)
    buffer_load_dwordx4 v[184:187], v3, s[44:47], s12 offen offset:0 nt
    s_waitcnt vmcnt(6)
    buffer_load_dwordx4 v[188:191], v3, s[44:47], s12 offen offset:128 nt
    s_waitcnt vmcnt(6)
    buffer_load_dwordx4 v[192:195], v3, s[44:47], s12 offen offset:256 nt
    s_waitcnt vmcnt(6)
    buffer_load_dwordx4 v[196:199], v3, s[44:47], s12 offen offset:384 nt
    s_waitcnt vmcnt(6)
    buffer_load_dwordx4 v[200:203], v3, s[44:47], s12 offen offset:512 nt
    s_waitcnt vmcnt(6)
    buffer_load_dwordx4 v[204:207], v3, s[44:47], s12 offen offset:640 nt
    s_add_u32 s14, s14, 32
    s_and_b32 s12, s14, 255
    s_mul_i32 s12, s12, 6144
    s_waitcnt vmcnt(6)
    buffer_load_dwordx4 v[208:211], v2, s[40:43], s12 offen offset:0 nt
    s_waitcnt vmcnt(6)
    buffer_load_dwordx4 v[212:215], v2, s[40:43], s12 offen offset:128 nt
    s_waitcnt vmcnt(6)
    buffer_load_dwordx4 v[216:219], v2, s[40:43], s12 offen offset:256 nt
    s_waitcnt vmcnt(6)
    buffer_load_dwordx4 v[220:223], v2, s[40:43], s12 offen offset:3072 nt
    s_waitcnt vmcnt(6)
    buffer_load_dwordx4 v[224:227], v2, s[40:43], s12 offen offset:3200 nt
    s_waitcnt vmcnt(6)
    buffer_load_dwordx4 v[228:231], v2, s[40:43], s12 offen offset:3328 nt
    s_waitcnt vmcnt(6)
    buffer_load_dwordx4 v[232:235], v3, s[44:47], s12 offen offset:0 nt
    s_waitcnt vmcnt(6)
    buffer_load_dwordx4 v[236:239], v3, s[44:47], s12 offen offset:128 nt
    s_waitcnt vmcnt(6)
    buffer_load_dwordx4 v[240:243], v3, s[44:47], s12 offen offset:256 nt
    s_waitcnt vmcnt(6)
    buffer_load_dwordx4 v[244:247], v3, s[44:47], s12 offen offset:384 nt
    s_waitcnt vmcnt(6)
    buffer_load_dwordx4 v[248:251], v3, s[44:47], s12 offen offset:512 nt
    s_waitcnt vmcnt(6)
    buffer_load_dwordx4 v[252:255], v3, s[44:47], s12 offen offset:640 nt
    s_add_u32 s14, s14, 32
    s_and_b32 s12, s14, 255
    s_mul_i32 s12, s12, 6144
    v_mov_b32 v29, 3968
    s_mov_b32 s15, 1600000
L_lw_q:
    ds_read_b32 v30, v29
    s_waitcnt lgkmcnt(0)
    v_cmp_eq_u32 vcc, 0, v30
    s_cbranch_vccz L_lw_q_ok
    s_sleep 1
    s_sub_u32 s15, s15, 1
    s_cmp_lg_u32 s15, 0
    s_cbranch_scc1 L_lw_q
L_lw_q_ok:
    v_bfe_u32 v29, v1, 4, 1
    v_lshlrev_b32 v29, 6, v29
    v_and_b32 v30, 3, v1
    v_lshl_add_u32 v29, v30, 4, v29
    s_mul_i32 s8, s13, 384
    s_add_u32 s8, s8, 2560
    v_add_u32 v29, s8, v29
    v_bfe_u32 v30, v1, 2, 2
    v_lshrrev_b32 v31, 5, v1
    v_sub_u32 v30, v30, v31
    v_mov_b32 v31, 3328
    v_cmp_eq_u32 vcc, 0, v30
    s_nop 1
    v_cndmask_b32 v24, v31, v29, vcc
    ds_read_b128 v[40:43], v24 offset:0
    ds_read_b128 v[44:47], v24 offset:128
    ds_read_b128 v[48:51], v24 offset:256
    v_cmp_eq_u32 vcc, 2, v30
    s_nop 1
    v_cndmask_b32 v24, v31, v29, vcc
    ds_read_b128 v[52:55], v24 offset:0
    ds_read_b128 v[56:59], v24 offset:128
    ds_read_b128 v[60:63], v24 offset:256
    s_waitcnt lgkmcnt(0)
    s_waitcnt vmcnt(42)
    v_mfma_f32_16x16x32_bf16 v[20:23], v[40:43], v[64:67], 0
    v_mfma_f32_16x16x32_bf16 v[20:23], v[44:47], v[68:71], v[20:23]
    v_mfma_f32_16x16x32_bf16 v[20:23], v[48:51], v[72:75], v[20:23]
    v_mfma_f32_16x16x32_bf16 v[20:23], v[52:55], v[76:79], v[20:23]
    v_mfma_f32_16x16x32_bf16 v[20:23], v[56:59], v[80:83], v[20:23]
    v_mfma_f32_16x16x32_bf16 v[20:23], v[60:63], v[84:87], v[20:23]
    buffer_load_dwordx4 v[64:67], v2, s[40:43], s12 offen offset:0 nt
    buffer_load_dwordx4 v[68:71], v2, s[40:43], s12 offen offset:128 nt
    buffer_load_dwordx4 v[72:75], v2, s[40:43], s12 offen offset:256 nt
    buffer_load_dwordx4 v[76:79], v2, s[40:43], s12 offen offset:3072 nt
    buffer_load_dwordx4 v[80:83], v2, s[40:43], s12 offen offset:3200 nt
    buffer_load_dwordx4 v[84:87], v2, s[40:43], s12 offen offset:3328 nt
    s_nop 1
    v_mov_b32_dpp v24, v20 quad_perm:[0,0,0,0] row_mask:0xf bank_mask:0xf
    v_mov_b32_dpp v29, v22 quad_perm:[2,2,2,2] row_mask:0xf bank_mask:0xf
    s_nop 0
    v_add_f32_dpp v24, v21, v24 quad_perm:[1,1,1,1] row_mask:0xf bank_mask:0xf
    v_add_f32_dpp v29, v23, v29 quad_perm:[3,3,3,3] row_mask:0xf bank_mask:0xf
    v_add_f32 v24, v24, v29
    v_cvt_pk_bf16_f32 v24, 0, v24
    v_mul_f32 v24, 0x3d93cd3a, v24
    v_cvt_pk_bf16_f32 v24, 0, v24
    v_mul_f32 v24, 0x3fb8aa3b, v24
    v_cmp_gt_f32 vcc, v24, v26
    s_cbranch_vccz L_norescale_1
    v_max_f32 v29, v24, v26
    s_nop 1
    v_max_f32_dpp v29, v29, v29 row_ror:4 row_mask:0xf bank_mask:0xf
    s_nop 1
    v_max_f32_dpp v29, v29, v29 row_ror:8 row_mask:0xf bank_mask:0xf
    v_mov_b32 v30, v29
    s_nop 1
    v_permlane16_swap_b32 v29, v30
    s_nop 1
    v_max_f32 v29, v29, v30
    v_mov_b32 v30, v29
    s_nop 1
    v_permlane32_swap_b32 v29, v30
    s_nop 1
    v_max_f32 v29, v29, v30
    v_sub_f32 v30, v26, v29
    v_exp_f32 v30, v30
    v_mov_b32 v26, v29
    v_mul_f32 v8, v8, v30
    v_mul_f32 v9, v9, v30
    v_mul_f32 v10, v10, v30
    v_mul_f32 v11, v11, v30
    v_mul_f32 v12, v12, v30
    v_mul_f32 v13, v13, v30
    v_mul_f32 v14, v14, v30
    v_mul_f32 v15, v15, v30
    v_mul_f32 v16, v16, v30
    v_mul_f32 v17, v17, v30
    v_mul_f32 v18, v18, v30
    v_mul_f32 v19, v19, v30
    v_mul_f32 v27, v27, v30
L_norescale_1:
    v_sub_f32 v24, v24, v26
    v_exp_f32 v24, v24
    s_nop 0
    v_cvt_pk_bf16_f32 v25, v24, v24
    v_add_f32 v27, v27, v24
    v_and_b32 v32, v25, v4
    v_and_b32 v33, v25, v5
    v_and_b32_dpp v34, v25, v6 row_shr:4 row_mask:0xf bank_mask:0xf bound_ctrl:0
    v_and_b32_dpp v35, v25, v7 row_shr:4 row_mask:0xf bank_mask:0xf bound_ctrl:0
    v_and_b32_dpp v36, v25, v4 row_shl:4 row_mask:0xf bank_mask:0xf bound_ctrl:0
    v_and_b32_dpp v37, v25, v5 row_shl:4 row_mask:0xf bank_mask:0xf bound_ctrl:0
    v_and_b32 v38, v25, v6
    v_and_b32 v39, v25, v7
    s_nop 1
    s_waitcnt vmcnt(42)
    v_mfma_f32_16x16x32_bf16 v[8:11], v[32:35], v[88:91], v[8:11]
    v_mfma_f32_16x16x32_bf16 v[12:15], v[32:35], v[92:95], v[12:15]
    v_mfma_f32_16x16x32_bf16 v[16:19], v[32:35], v[96:99], v[16:19]
    v_mfma_f32_16x16x32_bf16 v[8:11], v[36:39], v[100:103], v[8:11]
    v_mfma_f32_16x16x32_bf16 v[12:15], v[36:39], v[104:107], v[12:15]
    v_mfma_f32_16x16x32_bf16 v[16:19], v[36:39], v[108:111], v[16:19]
    buffer_load_dwordx4 v[88:91], v3, s[44:47], s12 offen offset:0 nt
    buffer_load_dwordx4 v[92:95], v3, s[44:47], s12 offen offset:128 nt
    s_waitcnt vmcnt(38)
    v_mfma_f32_16x16x32_bf16 v[20:23], v[40:43], v[112:115], 0
    v_mfma_f32_16x16x32_bf16 v[20:23], v[44:47], v[116:119], v[20:23]
    v_mfma_f32_16x16x32_bf16 v[20:23], v[48:51], v[120:123], v[20:23]
    v_mfma_f32_16x16x32_bf16 v[20:23], v[52:55], v[124:127], v[20:23]
    v_mfma_f32_16x16x32_bf16 v[20:23], v[56:59], v[128:131], v[20:23]
    v_mfma_f32_16x16x32_bf16 v[20:23], v[60:63], v[132:135], v[20:23]
    s_nop 7
    v_mov_b32_dpp v24, v20 quad_perm:[0,0,0,0] row_mask:0xf bank_mask:0xf
    v_mov_b32_dpp v29, v22 quad_perm:[2,2,2,2] row_mask:0xf bank_mask:0xf
    s_nop 0
    v_add_f32_dpp v24, v21, v24 quad_perm:[1,1,1,1] row_mask:0xf bank_mask:0xf
    v_add_f32_dpp v29, v23, v29 quad_perm:[3,3,3,3] row_mask:0xf bank_mask:0xf
    v_add_f32 v24, v24, v29
    v_cvt_pk_bf16_f32 v24, 0, v24
    v_mul_f32 v24, 0x3d93cd3a, v24
    v_cvt_pk_bf16_f32 v24, 0, v24
    v_mul_f32 v24, 0x3fb8aa3b, v24
    v_cmp_gt_f32 vcc, v24, v26
    s_cbranch_vccz L_norescale_2
    v_max_f32 v29, v24, v26
    s_nop 1
    v_max_f32_dpp v29, v29, v29 row_ror:4 row_mask:0xf bank_mask:0xf
    s_nop 1
    v_max_f32_dpp v29, v29, v29 row_ror:8 row_mask:0xf bank_mask:0xf
    v_mov_b32 v30, v29
    s_nop 1
    v_permlane16_swap_b32 v29, v30
    s_nop 1
    v_max_f32 v29, v29, v30
    v_mov_b32 v30, v29
    s_nop 1
    v_permlane32_swap_b32 v29, v30
    s_nop 1
    v_max_f32 v29, v29, v30
    v_sub_f32 v30, v26, v29
    v_exp_f32 v30, v30
    v_mov_b32 v26, v29
    v_mul_f32 v8, v8, v30
    v_mul_f32 v9, v9, v30
    v_mul_f32 v10, v10, v30
    v_mul_f32 v11, v11, v30
    v_mul_f32 v12, v12, v30
    v_mul_f32 v13, v13, v30
    v_mul_f32 v14, v14, v30
    v_mul_f32 v15, v15, v30
    v_mul_f32 v16, v16, v30
    v_mul_f32 v17, v17, v30
    v_mul_f32 v18, v18, v30
    v_mul_f32 v19, v19, v30
    v_mul_f32 v27, v27, v30
L_norescale_2:
    v_sub_f32 v24, v24, v26
    v_exp_f32 v24, v24
    s_nop 0
    v_cvt_pk_bf16_f32 v25, v24, v24
    v_add_f32 v27, v27, v24
    v_and_b32 v32, v25, v4
    v_and_b32 v33, v25, v5
    v_and_b32_dpp v34, v25, v6 row_shr:4 row_mask:0xf bank_mask:0xf bound_ctrl:0
    v_and_b32_dpp v35, v25, v7 row_shr:4 row_mask:0xf bank_mask:0xf bound_ctrl:0
    v_and_b32_dpp v36, v25, v4 row_shl:4 row_mask:0xf bank_mask:0xf bound_ctrl:0
    v_and_b32_dpp v37, v25, v5 row_shl:4 row_mask:0xf bank_mask:0xf bound_ctrl:0
    v_and_b32 v38, v25, v6
    v_and_b32 v39, v25, v7
    s_nop 1
    s_waitcnt vmcnt(32)
    v_mfma_f32_16x16x32_bf16 v[8:11], v[32:35], v[136:139], v[8:11]
    v_mfma_f32_16x16x32_bf16 v[12:15], v[32:35], v[140:143], v[12:15]
    v_mfma_f32_16x16x32_bf16 v[16:19], v[32:35], v[144:147], v[16:19]
    v_mfma_f32_16x16x32_bf16 v[8:11], v[36:39], v[148:151], v[8:11]
    v_mfma_f32_16x16x32_bf16 v[12:15], v[36:39], v[152:155], v[12:15]
    v_mfma_f32_16x16x32_bf16 v[16:19], v[36:39], v[156:159], v[16:19]
    s_waitcnt vmcnt(26)
    v_mfma_f32_16x16x32_bf16 v[20:23], v[40:43], v[160:163], 0
    v_mfma_f32_16x16x32_bf16 v[20:23], v[44:47], v[164:167], v[20:23]
    v_mfma_f32_16x16x32_bf16 v[20:23], v[48:51], v[168:171], v[20:23]
    v_mfma_f32_16x16x32_bf16 v[20:23], v[52:55], v[172:175], v[20:23]
    v_mfma_f32_16x16x32_bf16 v[20:23], v[56:59], v[176:179], v[20:23]
    v_mfma_f32_16x16x32_bf16 v[20:23], v[60:63], v[180:183], v[20:23]
    s_nop 7
    v_mov_b32_dpp v24, v20 quad_perm:[0,0,0,0] row_mask:0xf bank_mask:0xf
    v_mov_b32_dpp v29, v22 quad_perm:[2,2,2,2] row_mask:0xf bank_mask:0xf
    s_nop 0
    v_add_f32_dpp v24, v21, v24 quad_perm:[1,1,1,1] row_mask:0xf bank_mask:0xf
    v_add_f32_dpp v29, v23, v29 quad_perm:[3,3,3,3] row_mask:0xf bank_mask:0xf
    v_add_f32 v24, v24, v29
    v_cvt_pk_bf16_f32 v24, 0, v24
    v_mul_f32 v24, 0x3d93cd3a, v24
    v_cvt_pk_bf16_f32 v24, 0, v24
    v_mul_f32 v24, 0x3fb8aa3b, v24
    v_cmp_gt_f32 vcc, v24, v26
    s_cbranch_vccz L_norescale_3
    v_max_f32 v29, v24, v26
    s_nop 1
    v_max_f32_dpp v29, v29, v29 row_ror:4 row_mask:0xf bank_mask:0xf
    s_nop 1
    v_max_f32_dpp v29, v29, v29 row_ror:8 row_mask:0xf bank_mask:0xf
    v_mov_b32 v30, v29
    s_nop 1
    v_permlane16_swap_b32 v29, v30
    s_nop 1
    v_max_f32 v29, v29, v30
    v_mov_b32 v30, v29
    s_nop 1
    v_permlane32_swap_b32 v29, v30
    s_nop 1
    v_max_f32 v29, v29, v30
    v_sub_f32 v30, v26, v29
    v_exp_f32 v30, v30
    v_mov_b32 v26, v29
    v_mul_f32 v8, v8, v30
    v_mul_f32 v9, v9, v30
    v_mul_f32 v10, v10, v30
    v_mul_f32 v11, v11, v30
    v_mul_f32 v12, v12, v30
    v_mul_f32 v13, v13, v30
    v_mul_f32 v14, v14, v30
    v_mul_f32 v15, v15, v30
    v_mul_f32 v16, v16, v30
    v_mul_f32 v17, v17, v30
    v_mul_f32 v18, v18, v30
    v_mul_f32 v19, v19, v30
    v_mul_f32 v27, v27, v30
L_norescale_3:
    v_sub_f32 v24, v24, v26
    v_exp_f32 v24, v24
    s_nop 0
    v_cvt_pk_bf16_f32 v25, v24, v24
    v_add_f32 v27, v27, v24
    v_and_b32 v32, v25, v4
    v_and_b32 v33, v25, v5
    v_and_b32_dpp v34, v25, v6 row_shr:4 row_mask:0xf bank_mask:0xf bound_ctrl:0
    v_and_b32_dpp v35, v25, v7 row_shr:4 row_mask:0xf bank_mask:0xf bound_ctrl:0
    v_and_b32_dpp v36, v25, v4 row_shl:4 row_mask:0xf bank_mask:0xf bound_ctrl:0
    v_and_b32_dpp v37, v25, v5 row_shl:4 row_mask:0xf bank_mask:0xf bound_ctrl:0
    v_and_b32 v38, v25, v6
    v_and_b32 v39, v25, v7
    s_nop 1
    s_waitcnt vmcnt(20)
    v_mfma_f32_16x16x32_bf16 v[8:11], v[32:35], v[184:187], v[8:11]
    v_mfma_f32_16x16x32_bf16 v[12:15], v[32:35], v[188:191], v[12:15]
    v_mfma_f32_16x16x32_bf16 v[16:19], v[32:35], v[192:195], v[16:19]
    v_mfma_f32_16x16x32_bf16 v[8:11], v[36:39], v[196:199], v[8:11]
    v_mfma_f32_16x16x32_bf16 v[12:15], v[36:39], v[200:203], v[12:15]
    v_mfma_f32_16x16x32_bf16 v[16:19], v[36:39], v[204:207], v[16:19]
    s_waitcnt vmcnt(14)
    v_mfma_f32_16x16x32_bf16 v[20:23], v[40:43], v[208:211], 0
    v_mfma_f32_16x16x32_bf16 v[20:23], v[44:47], v[212:215], v[20:23]
    v_mfma_f32_16x16x32_bf16 v[20:23], v[48:51], v[216:219], v[20:23]
    v_mfma_f32_16x16x32_bf16 v[20:23], v[52:55], v[220:223], v[20:23]
    v_mfma_f32_16x16x32_bf16 v[20:23], v[56:59], v[224:227], v[20:23]
    v_mfma_f32_16x16x32_bf16 v[20:23], v[60:63], v[228:231], v[20:23]
    s_nop 7
    v_mov_b32_dpp v24, v20 quad_perm:[0,0,0,0] row_mask:0xf bank_mask:0xf
    v_mov_b32_dpp v29, v22 quad_perm:[2,2,2,2] row_mask:0xf bank_mask:0xf
    s_nop 0
    v_add_f32_dpp v24, v21, v24 quad_perm:[1,1,1,1] row_mask:0xf bank_mask:0xf
    v_add_f32_dpp v29, v23, v29 quad_perm:[3,3,3,3] row_mask:0xf bank_mask:0xf
    v_add_f32 v24, v24, v29
    v_cvt_pk_bf16_f32 v24, 0, v24
    v_mul_f32 v24, 0x3d93cd3a, v24
    v_cvt_pk_bf16_f32 v24, 0, v24
    v_mul_f32 v24, 0x3fb8aa3b, v24
    v_cmp_gt_f32 vcc, v24, v26
    s_cbranch_vccz L_norescale_4
    v_max_f32 v29, v24, v26
    s_nop 1
    v_max_f32_dpp v29, v29, v29 row_ror:4 row_mask:0xf bank_mask:0xf
    s_nop 1
    v_max_f32_dpp v29, v29, v29 row_ror:8 row_mask:0xf bank_mask:0xf
    v_mov_b32 v30, v29
    s_nop 1
    v_permlane16_swap_b32 v29, v30
    s_nop 1
    v_max_f32 v29, v29, v30
    v_mov_b32 v30, v29
    s_nop 1
    v_permlane32_swap_b32 v29, v30
    s_nop 1
    v_max_f32 v29, v29, v30
    v_sub_f32 v30, v26, v29
    v_exp_f32 v30, v30
    v_mov_b32 v26, v29
    v_mul_f32 v8, v8, v30
    v_mul_f32 v9, v9, v30
    v_mul_f32 v10, v10, v30
    v_mul_f32 v11, v11, v30
    v_mul_f32 v12, v12, v30
    v_mul_f32 v13, v13, v30
    v_mul_f32 v14, v14, v30
    v_mul_f32 v15, v15, v30
    v_mul_f32 v16, v16, v30
    v_mul_f32 v17, v17, v30
    v_mul_f32 v18, v18, v30
    v_mul_f32 v19, v19, v30
    v_mul_f32 v27, v27, v30
L_norescale_4:
    v_sub_f32 v24, v24, v26
    v_exp_f32 v24, v24
    s_nop 0
    v_cvt_pk_bf16_f32 v25, v24, v24
    v_add_f32 v27, v27, v24
    v_and_b32 v32, v25, v4
    v_and_b32 v33, v25, v5
    v_and_b32_dpp v34, v25, v6 row_shr:4 row_mask:0xf bank_mask:0xf bound_ctrl:0
    v_and_b32_dpp v35, v25, v7 row_shr:4 row_mask:0xf bank_mask:0xf bound_ctrl:0
    v_and_b32_dpp v36, v25, v4 row_shl:4 row_mask:0xf bank_mask:0xf bound_ctrl:0
    v_and_b32_dpp v37, v25, v5 row_shl:4 row_mask:0xf bank_mask:0xf bound_ctrl:0
    v_and_b32 v38, v25, v6
    v_and_b32 v39, v25, v7
    s_nop 1
    s_waitcnt vmcnt(8)
    v_mfma_f32_16x16x32_bf16 v[8:11], v[32:35], v[232:235], v[8:11]
    v_mfma_f32_16x16x32_bf16 v[12:15], v[32:35], v[236:239], v[12:15]
    v_mfma_f32_16x16x32_bf16 v[16:19], v[32:35], v[240:243], v[16:19]
    v_mfma_f32_16x16x32_bf16 v[8:11], v[36:39], v[244:247], v[8:11]
    v_mfma_f32_16x16x32_bf16 v[12:15], v[36:39], v[248:251], v[12:15]
    v_mfma_f32_16x16x32_bf16 v[16:19], v[36:39], v[252:255], v[16:19]
    s_mov_b32 s56, 4
    s_cmp_ge_u32 s6, 5
    s_cselect_b32 s58, 472, -1
    s_mul_i32 s9, s7, 1536
    s_add_u32 s9, s9, 4096
    v_lshrrev_b32 v29, 5, v1
    v_mul_u32_u24 v29, 768, v29
    v_and_b32 v30, 7, v1
    v_lshl_add_u32 v29, v30, 5, v29
    v_bfe_u32 v31, v1, 4, 1
    v_lshl_add_u32 v29, v31, 4, v29
    v_add_u32 v216, s9, v29
    s_lshl_b32 s8, s7, 3
    s_add_u32 s8, s8, 3904
    v_mov_b32 v217, s8
    s_lshl_b32 s8, s7, 5
    s_add_u32 s8, s8, 3904
    v_mov_b32 v219, s8
    v_lshrrev_b32 v29, 2, v1
    v_mul_u32_u24 v29, 48, v29
    v_and_b32 v31, 3, v1
    v_lshl_add_u32 v29, v31, 4, v29
    s_mul_i32 s8, s7, 6144
    s_add_u32 s8, s8, 4096
    v_add_u32 v218, s8, v29
    v_cmp_eq_u32 s[68:69], 3, v31
    v_lshlrev_b32 v220, 4, v1
    s_lshl_b32 s64, s2, 11
    s_lshl_b32 s9, s7, 10
    s_add_u32 s64, s64, s9
    s_add_u32 s64, s64, 524288
    s_add_u32 s9, s9, 16384
    v_add_u32 v223, s9, v220
    v_bfe_u32 v30, v1, 3, 1
    v_bfe_u32 v29, v1, 2, 1
    v_lshlrev_b32 v29, 11, v29
    v_lshl_add_u32 v29, v30, 10, v29
    v_lshl_add_u32 v29, v31, 4, v29
    v_lshrrev_b32 v30, 4, v1
    v_lshl_add_u32 v221, v30, 6, v29
    v_add_u32 v224, 4096, v221
    v_add_u32 v225, 8192, v221
    v_add_u32 v226, 12288, v221
    s_lshl_b32 s65, s4, 14
    s_lshl_b32 s9, s7, 8
    s_add_u32 s65, s65, s9
    s_add_u32 s65, s65, 524288
    s_lshl_b32 s66, s6, 15
    s_lshl_b32 s9, s4, 10
    s_add_u32 s66, s66, s9
    s_add_u32 s66, s66, 1048576
    s_mov_b32 s52, s24
    s_and_b32 s53, s25, 0xffff
    s_mov_b32 s54, 7864320
    s_mov_b32 s55, 0x20000
    v_mul_u32_u24 v30, 15360, v30
    v_and_b32 v29, 15, v1
    v_lshl_add_u32 v222, v29, 4, v30
    s_mul_i32 s67, s4, 245760
    s_mul_i32 s9, s7, 61440
    s_add_u32 s67, s67, s9
    s_lshl_b32 s9, s6, 8
    s_add_u32 s67, s67, s9
    v_mov_b32 v227, 3968
    v_mov_b32 v228, 1
    s_mov_b32 s11, 0
.p2align 3
L_loop:
    s_cmp_eq_u32 s11, s13
    s_cbranch_scc1 L_sameb
    s_nop 3
    s_nop 1
    v_add_f32_dpp v27, v27, v27 row_ror:4 row_mask:0xf bank_mask:0xf
    s_nop 1
    v_add_f32_dpp v27, v27, v27 row_ror:8 row_mask:0xf bank_mask:0xf
    v_mov_b32 v30, v27
    s_nop 1
    v_permlane16_swap_b32 v27, v30
    s_nop 1
    v_add_f32 v27, v27, v30
    v_mov_b32 v30, v27
    s_nop 1
    v_permlane32_swap_b32 v27, v30
    s_nop 1
    v_add_f32 v27, v27, v30
    s_mov_b64 exec, 1
    ds_write_b64 v217, v[26:27] offset:0
    s_mov_b64 exec, s[72:73]
    ds_write_b128 v216, v[8:11] offset:0
    ds_write_b128 v216, v[12:15] offset:256
    ds_write_b128 v216, v[16:19] offset:512
    s_mov_b64 exec, -1
    s_waitcnt lgkmcnt(0)
    v_mov_b32 v8, 0
    v_mov_b32 v9, 0
    v_mov_b32 v10, 0
    v_mov_b32 v11, 0
    v_mov_b32 v12, 0
    v_mov_b32 v13, 0
    v_mov_b32 v14, 0
    v_mov_b32 v15, 0
    v_mov_b32 v16, 0
    v_mov_b32 v17, 0
    v_mov_b32 v18, 0
    v_mov_b32 v19, 0
    v_mov_b32 v26, 0xff7fffff
    v_mov_b32 v27, 0
    s_mov_b32 s13, 1
    v_bfe_u32 v29, v1, 4, 1
    v_lshlrev_b32 v29, 6, v29
    v_and_b32 v30, 3, v1
    v_lshl_add_u32 v29, v30, 4, v29
    s_mul_i32 s8, s13, 384
    s_add_u32 s8, s8, 2560
    v_add_u32 v29, s8, v29
    v_bfe_u32 v30, v1, 2, 2
    v_lshrrev_b32 v31, 5, v1
    v_sub_u32 v30, v30, v31
    v_mov_b32 v31, 3328
    v_cmp_eq_u32 vcc, 0, v30
    s_nop 1
    v_cndmask_b32 v24, v31, v29, vcc
    ds_read_b128 v[40:43], v24 offset:0
    ds_read_b128 v[44:47], v24 offset:128
    ds_read_b128 v[48:51], v24 offset:256
    v_cmp_eq_u32 vcc, 2, v30
    s_nop 1
    v_cndmask_b32 v24, v31, v29, vcc
    ds_read_b128 v[52:55], v24 offset:0
    ds_read_b128 v[56:59], v24 offset:128
    ds_read_b128 v[60:63], v24 offset:256
    s_waitcnt lgkmcnt(0)
L_sameb:
    s_waitcnt vmcnt(7)
    v_mfma_f32_16x16x32_bf16 v[20:23], v[40:43], v[64:67], 0
    buffer_load_dwordx4 v[96:99], v3, s[44:47], s12 offen offset:256 nt
    s_waitcnt vmcnt(7)
    v_mfma_f32_16x16x32_bf16 v[20:23], v[44:47], v[68:71], v[20:23]
    buffer_load_dwordx4 v[100:103], v3, s[44:47], s12 offen offset:384 nt
    s_waitcnt vmcnt(7)
    v_mfma_f32_16x16x32_bf16 v[20:23], v[48:51], v[72:75], v[20:23]
    buffer_load_dwordx4 v[104:107], v3, s[44:47], s12 offen offset:512 nt
    s_cmp_lt_u32 s56, 12
    s_cbranch_scc1 L_notk
    s_cmp_ge_u32 s14, s58
    s_mov_b32 s77, 0x10000
    s_cbranch_scc1 L_notk
    s_mov_b32 s77, 1
    s_atomic_add s77, s[98:99], 0x0 glc
L_notk:
    s_waitcnt vmcnt(7)
    v_mfma_f32_16x16x32_bf16 v[20:23], v[52:55], v[76:79], v[20:23]
    buffer_load_dwordx4 v[108:111], v3, s[44:47], s12 offen offset:640 nt
    s_add_u32 s56, s56, 1
    s_lshl_b32 s14, s56, 5
    s_add_u32 s14, s14, s57
    s_cmp_lt_u32 s56, 13
    s_cbranch_scc1 L_go
    s_waitcnt lgkmcnt(0)
    s_add_u32 s14, s77, 416
    s_cmp_ge_u32 s14, 512
    s_cbranch_scc1 L_last
L_go:
    s_lshr_b32 s11, s14, 8
    s_add_u32 s8, s14, s74
    s_and_b32 s8, s8, 255
    s_mul_i32 s75, s8, 6144
    s_mul_i32 s8, s11, 50331648
    s_add_u32 s75, s75, s8
    s_waitcnt vmcnt(7)
    v_mfma_f32_16x16x32_bf16 v[20:23], v[56:59], v[80:83], v[20:23]
    buffer_load_dwordx4 v[64:67], v2, s[40:43], s75 offen offset:0 nt
    s_waitcnt vmcnt(7)
    v_mfma_f32_16x16x32_bf16 v[20:23], v[60:63], v[84:87], v[20:23]
    buffer_load_dwordx4 v[68:71], v2, s[40:43], s75 offen offset:128 nt
    s_nop 6
    v_mov_b32_dpp v24, v20 quad_perm:[0,0,0,0] row_mask:0xf bank_mask:0xf
    v_mov_b32_dpp v29, v22 quad_perm:[2,2,2,2] row_mask:0xf bank_mask:0xf
    s_nop 0
    v_add_f32_dpp v24, v21, v24 quad_perm:[1,1,1,1] row_mask:0xf bank_mask:0xf
    v_add_f32_dpp v29, v23, v29 quad_perm:[3,3,3,3] row_mask:0xf bank_mask:0xf
    v_add_f32 v24, v24, v29
    v_cvt_pk_bf16_f32 v24, 0, v24
    v_mul_f32 v24, 0x3d93cd3a, v24
    v_cvt_pk_bf16_f32 v24, 0, v24
    v_mul_f32 v24, 0x3fb8aa3b, v24
    v_cmp_gt_f32 vcc, v24, v26
    s_cbranch_vccz L_norescale_5
    v_max_f32 v29, v24, v26
    s_nop 1
    v_max_f32_dpp v29, v29, v29 row_ror:4 row_mask:0xf bank_mask:0xf
    s_nop 1
    v_max_f32_dpp v29, v29, v29 row_ror:8 row_mask:0xf bank_mask:0xf
    v_mov_b32 v30, v29
    s_nop 1
    v_permlane16_swap_b32 v29, v30
    s_nop 1
    v_max_f32 v29, v29, v30
    v_mov_b32 v30, v29
    s_nop 1
    v_permlane32_swap_b32 v29, v30
    s_nop 1
    v_max_f32 v29, v29, v30
    v_sub_f32 v30, v26, v29
    v_exp_f32 v30, v30
    v_mov_b32 v26, v29
    v_mul_f32 v8, v8, v30
    v_mul_f32 v9, v9, v30
    v_mul_f32 v10, v10, v30
    v_mul_f32 v11, v11, v30
    v_mul_f32 v12, v12, v30
    v_mul_f32 v13, v13, v30
    v_mul_f32 v14, v14, v30
    v_mul_f32 v15, v15, v30
    v_mul_f32 v16, v16, v30
    v_mul_f32 v17, v17, v30
    v_mul_f32 v18, v18, v30
    v_mul_f32 v19, v19, v30
    v_mul_f32 v27, v27, v30
L_norescale_5:
    v_sub_f32 v24, v24, v26
    v_exp_f32 v24, v24
    s_nop 0
    v_cvt_pk_bf16_f32 v25, v24, v24
    v_add_f32 v27, v27, v24
    v_and_b32 v32, v25, v4
    v_and_b32 v33, v25, v5
    v_and_b32_dpp v34, v25, v6 row_shr:4 row_mask:0xf bank_mask:0xf bound_ctrl:0
    v_and_b32_dpp v35, v25, v7 row_shr:4 row_mask:0xf bank_mask:0xf bound_ctrl:0
    v_and_b32_dpp v36, v25, v4 row_shl:4 row_mask:0xf bank_mask:0xf bound_ctrl:0
    v_and_b32_dpp v37, v25, v5 row_shl:4 row_mask:0xf bank_mask:0xf bound_ctrl:0
    v_and_b32 v38, v25, v6
    v_and_b32 v39, v25, v7
    s_nop 1
    s_waitcnt vmcnt(7)
    v_mfma_f32_16x16x32_bf16 v[8:11], v[32:35], v[88:91], v[8:11]
    buffer_load_dwordx4 v[72:75], v2, s[40:43], s75 offen offset:256 nt
    s_waitcnt vmcnt(7)
    v_mfma_f32_16x16x32_bf16 v[12:15], v[32:35], v[92:95], v[12:15]
    buffer_load_dwordx4 v[76:79], v2, s[40:43], s75 offen offset:3072 nt
    s_waitcnt vmcnt(7)
    v_mfma_f32_16x16x32_bf16 v[16:19], v[32:35], v[96:99], v[16:19]
    buffer_load_dwordx4 v[80:83], v2, s[40:43], s75 offen offset:3200 nt
    s_waitcnt vmcnt(7)
    v_mfma_f32_16x16x32_bf16 v[8:11], v[36:39], v[100:103], v[8:11]
    buffer_load_dwordx4 v[84:87], v2, s[40:43], s75 offen offset:3328 nt
    s_waitcnt vmcnt(7)
    v_mfma_f32_16x16x32_bf16 v[12:15], v[36:39], v[104:107], v[12:15]
    buffer_load_dwordx4 v[88:91], v3, s[44:47], s75 offen offset:0 nt
    s_waitcnt vmcnt(7)
    v_mfma_f32_16x16x32_bf16 v[16:19], v[36:39], v[108:111], v[16:19]
    buffer_load_dwordx4 v[92:95], v3, s[44:47], s75 offen offset:128 nt
    s_mov_b32 s12, s75
    s_branch L_loop
L_last:
    ds_write_b32 v227, v228 offset:28
    s_cmp_ge_u32 s6, 5
    s_cbranch_scc1 L_last_n
    buffer_load_dwordx4 v[112:115], v222, s[52:55], s67 offen offset:0 nt
    buffer_load_dwordx4 v[116:119], v222, s[52:55], s67 offen offset:1280 nt
    buffer_load_dwordx4 v[120:123], v222, s[52:55], s67 offen offset:2560 nt
    s_add_u32 s67, s67, 3840
    buffer_load_dwordx4 v[124:127], v222, s[52:55], s67 offen offset:0 nt
    buffer_load_dwordx4 v[128:131], v222, s[52:55], s67 offen offset:1280 nt
    buffer_load_dwordx4 v[132:135], v222, s[52:55], s67 offen offset:2560 nt
    s_add_u32 s67, s67, 3840
    s_waitcnt vmcnt(13)
    v_mfma_f32_16x16x32_bf16 v[20:23], v[56:59], v[80:83], v[20:23]
    s_waitcnt vmcnt(12)
    v_mfma_f32_16x16x32_bf16 v[20:23], v[60:63], v[84:87], v[20:23]
    s_nop 7
    v_mov_b32_dpp v24, v20 quad_perm:[0,0,0,0] row_mask:0xf bank_mask:0xf
    v_mov_b32_dpp v29, v22 quad_perm:[2,2,2,2] row_mask:0xf bank_mask:0xf
    s_nop 0
    v_add_f32_dpp v24, v21, v24 quad_perm:[1,1,1,1] row_mask:0xf bank_mask:0xf
    v_add_f32_dpp v29, v23, v29 quad_perm:[3,3,3,3] row_mask:0xf bank_mask:0xf
    v_add_f32 v24, v24, v29
    v_cvt_pk_bf16_f32 v24, 0, v24
    v_mul_f32 v24, 0x3d93cd3a, v24
    v_cvt_pk_bf16_f32 v24, 0, v24
    v_mul_f32 v24, 0x3fb8aa3b, v24
    v_cmp_gt_f32 vcc, v24, v26
    s_cbranch_vccz L_norescale_6
    v_max_f32 v29, v24, v26
    s_nop 1
    v_max_f32_dpp v29, v29, v29 row_ror:4 row_mask:0xf bank_mask:0xf
    s_nop 1
    v_max_f32_dpp v29, v29, v29 row_ror:8 row_mask:0xf bank_mask:0xf
    v_mov_b32 v30, v29
    s_nop 1
    v_permlane16_swap_b32 v29, v30
    s_nop 1
    v_max_f32 v29, v29, v30
    v_mov_b32 v30, v29
    s_nop 1
    v_permlane32_swap_b32 v29, v30
    s_nop 1
    v_max_f32 v29, v29, v30
    v_sub_f32 v30, v26, v29
    v_exp_f32 v30, v30
    v_mov_b32 v26, v29
    v_mul_f32 v8, v8, v30
    v_mul_f32 v9, v9, v30
    v_mul_f32 v10, v10, v30
    v_mul_f32 v11, v11, v30
    v_mul_f32 v12, v12, v30
    v_mul_f32 v13, v13, v30
    v_mul_f32 v14, v14, v30
    v_mul_f32 v15, v15, v30
    v_mul_f32 v16, v16, v30
    v_mul_f32 v17, v17, v30
    v_mul_f32 v18, v18, v30
    v_mul_f32 v19, v19, v30
    v_mul_f32 v27, v27, v30
L_norescale_6:
    v_sub_f32 v24, v24, v26
    v_exp_f32 v24, v24
    s_nop 0
    v_cvt_pk_bf16_f32 v25, v24, v24
    v_add_f32 v27, v27, v24
    v_and_b32 v32, v25, v4
    v_and_b32 v33, v25, v5
    v_and_b32_dpp v34, v25, v6 row_shr:4 row_mask:0xf bank_mask:0xf bound_ctrl:0
    v_and_b32_dpp v35, v25, v7 row_shr:4 row_mask:0xf bank_mask:0xf bound_ctrl:0
    v_and_b32_dpp v36, v25, v4 row_shl:4 row_mask:0xf bank_mask:0xf bound_ctrl:0
    v_and_b32_dpp v37, v25, v5 row_shl:4 row_mask:0xf bank_mask:0xf bound_ctrl:0
    v_and_b32 v38, v25, v6
    v_and_b32 v39, v25, v7
    s_nop 1
    s_nop 1
    v_add_f32_dpp v27, v27, v27 row_ror:4 row_mask:0xf bank_mask:0xf
    s_nop 1
    v_add_f32_dpp v27, v27, v27 row_ror:8 row_mask:0xf bank_mask:0xf
    v_mov_b32 v30, v27
    s_nop 1
    v_permlane16_swap_b32 v27, v30
    s_nop 1
    v_add_f32 v27, v27, v30
    v_mov_b32 v30, v27
    s_nop 1
    v_permlane32_swap_b32 v27, v30
    s_nop 1
    v_add_f32 v27, v27, v30
    s_waitcnt vmcnt(11)
    v_mfma_f32_16x16x32_bf16 v[8:11], v[32:35], v[88:91], v[8:11]
    s_waitcnt vmcnt(10)
    v_mfma_f32_16x16x32_bf16 v[12:15], v[32:35], v[92:95], v[12:15]
    s_waitcnt vmcnt(9)
    v_mfma_f32_16x16x32_bf16 v[16:19], v[32:35], v[96:99], v[16:19]
    s_waitcnt vmcnt(8)
    v_mfma_f32_16x16x32_bf16 v[8:11], v[36:39], v[100:103], v[8:11]
    s_waitcnt vmcnt(7)
    v_mfma_f32_16x16x32_bf16 v[12:15], v[36:39], v[104:107], v[12:15]
    s_waitcnt vmcnt(6)
    v_mfma_f32_16x16x32_bf16 v[16:19], v[36:39], v[108:111], v[16:19]
    s_branch L_last_e
L_last_n:
    s_waitcnt vmcnt(7)
    v_mfma_f32_16x16x32_bf16 v[20:23], v[56:59], v[80:83], v[20:23]
    s_waitcnt vmcnt(6)
    v_mfma_f32_16x16x32_bf16 v[20:23], v[60:63], v[84:87], v[20:23]
    s_nop 7
    v_mov_b32_dpp v24, v20 quad_perm:[0,0,0,0] row_mask:0xf bank_mask:0xf
    v_mov_b32_dpp v29, v22 quad_perm:[2,2,2,2] row_mask:0xf bank_mask:0xf
    s_nop 0
    v_add_f32_dpp v24, v21, v24 quad_perm:[1,1,1,1] row_mask:0xf bank_mask:0xf
    v_add_f32_dpp v29, v23, v29 quad_perm:[3,3,3,3] row_mask:0xf bank_mask:0xf
    v_add_f32 v24, v24, v29
    v_cvt_pk_bf16_f32 v24, 0, v24
    v_mul_f32 v24, 0x3d93cd3a, v24
    v_cvt_pk_bf16_f32 v24, 0, v24
    v_mul_f32 v24, 0x3fb8aa3b, v24
    v_cmp_gt_f32 vcc, v24, v26
    s_cbranch_vccz L_norescale_7
    v_max_f32 v29, v24, v26
    s_nop 1
    v_max_f32_dpp v29, v29, v29 row_ror:4 row_mask:0xf bank_mask:0xf
    s_nop 1
    v_max_f32_dpp v29, v29, v29 row_ror:8 row_mask:0xf bank_mask:0xf
    v_mov_b32 v30, v29
    s_nop 1
    v_permlane16_swap_b32 v29, v30
    s_nop 1
    v_max_f32 v29, v29, v30
    v_mov_b32 v30, v29
    s_nop 1
    v_permlane32_swap_b32 v29, v30
    s_nop 1
    v_max_f32 v29, v29, v30
    v_sub_f32 v30, v26, v29
    v_exp_f32 v30, v30
    v_mov_b32 v26, v29
    v_mul_f32 v8, v8, v30
    v_mul_f32 v9, v9, v30
    v_mul_f32 v10, v10, v30
    v_mul_f32 v11, v11, v30
    v_mul_f32 v12, v12, v30
    v_mul_f32 v13, v13, v30
    v_mul_f32 v14, v14, v30
    v_mul_f32 v15, v15, v30
    v_mul_f32 v16, v16, v30
    v_mul_f32 v17, v17, v30
    v_mul_f32 v18, v18, v30
    v_mul_f32 v19, v19, v30
    v_mul_f32 v27, v27, v30
L_norescale_7:
    v_sub_f32 v24, v24, v26
    v_exp_f32 v24, v24
    s_nop 0
    v_cvt_pk_bf16_f32 v25, v24, v24
    v_add_f32 v27, v27, v24
    v_and_b32 v32, v25, v4
    v_and_b32 v33, v25, v5
    v_and_b32_dpp v34, v25, v6 row_shr:4 row_mask:0xf bank_mask:0xf bound_ctrl:0
    v_and_b32_dpp v35, v25, v7 row_shr:4 row_mask:0xf bank_mask:0xf bound_ctrl:0
    v_and_b32_dpp v36, v25, v4 row_shl:4 row_mask:0xf bank_mask:0xf bound_ctrl:0
    v_and_b32_dpp v37, v25, v5 row_shl:4 row_mask:0xf bank_mask:0xf bound_ctrl:0
    v_and_b32 v38, v25, v6
    v_and_b32 v39, v25, v7
    s_nop 1
    s_nop 1
    v_add_f32_dpp v27, v27, v27 row_ror:4 row_mask:0xf bank_mask:0xf
    s_nop 1
    v_add_f32_dpp v27, v27, v27 row_ror:8 row_mask:0xf bank_mask:0xf
    v_mov_b32 v30, v27
    s_nop 1
    v_permlane16_swap_b32 v27, v30
    s_nop 1
    v_add_f32 v27, v27, v30
    v_mov_b32 v30, v27
    s_nop 1
    v_permlane32_swap_b32 v27, v30
    s_nop 1
    v_add_f32 v27, v27, v30
    s_waitcnt vmcnt(5)
    v_mfma_f32_16x16x32_bf16 v[8:11], v[32:35], v[88:91], v[8:11]
    s_waitcnt vmcnt(4)
    v_mfma_f32_16x16x32_bf16 v[12:15], v[32:35], v[92:95], v[12:15]
    s_waitcnt vmcnt(3)
    v_mfma_f32_16x16x32_bf16 v[16:19], v[32:35], v[96:99], v[16:19]
    s_waitcnt vmcnt(2)
    v_mfma_f32_16x16x32_bf16 v[8:11], v[36:39], v[100:103], v[8:11]
    s_waitcnt vmcnt(1)
    v_mfma_f32_16x16x32_bf16 v[12:15], v[36:39], v[104:107], v[12:15]
    s_waitcnt vmcnt(0)
    v_mfma_f32_16x16x32_bf16 v[16:19], v[36:39], v[108:111], v[16:19]
L_last_e:
    s_nop 4
    s_mov_b64 exec, 1
    ds_write_b64 v217, v[26:27] offset:32
    s_mov_b64 exec, s[72:73]
    ds_write_b128 v216, v[8:11] offset:6144
    ds_write_b128 v216, v[12:15] offset:6400
    ds_write_b128 v216, v[16:19] offset:6656
    s_mov_b64 exec, -1
    s_waitcnt lgkmcnt(0)
    s_barrier
    s_cmp_ge_u32 s7, 2
    s_cbranch_scc1 L_published
    ds_read_b128 v[176:179], v219
    ds_read_b128 v[180:183], v219 offset:16
    ds_read_b128 v[184:187], v218 offset:0
    ds_read_b128 v[188:191], v218 offset:768
    ds_read_b128 v[192:195], v218 offset:1536
    ds_read_b128 v[196:199], v218 offset:2304
    ds_read_b128 v[200:203], v218 offset:3072
    ds_read_b128 v[204:207], v218 offset:3840
    ds_read_b128 v[208:211], v218 offset:4608
    ds_read_b128 v[212:215], v218 offset:5376
    s_waitcnt lgkmcnt(8)
    v_max_f32 v24, v176, v178
    v_max3_f32 v24, v180, v182, v24
    v_sub_f32 v176, v176, v24
    v_sub_f32 v178, v178, v24
    v_sub_f32 v180, v180, v24
    v_sub_f32 v182, v182, v24
    v_exp_f32 v176, v176
    v_exp_f32 v178, v178
    v_exp_f32 v180, v180
    v_exp_f32 v182, v182
    s_nop 0
    v_mul_f32 v25, v176, v177
    v_fmac_f32 v25, v178, v179
    v_fmac_f32 v25, v180, v181
    v_fmac_f32 v25, v182, v183
    s_waitcnt lgkmcnt(6)
    v_pk_add_f32 v[184:185], v[184:185], v[188:189]
    v_pk_add_f32 v[186:187], v[186:187], v[190:191]
    v_pk_mul_f32 v[20:21], v[184:185], v[176:177] op_sel_hi:[1,0]
    v_pk_mul_f32 v[22:23], v[186:187], v[176:177] op_sel_hi:[1,0]
    s_waitcnt lgkmcnt(4)
    v_pk_add_f32 v[192:193], v[192:193], v[196:197]
    v_pk_add_f32 v[194:195], v[194:195], v[198:199]
    v_pk_fma_f32 v[20:21], v[192:193], v[178:179], v[20:21] op_sel_hi:[1,0,1]
    v_pk_fma_f32 v[22:23], v[194:195], v[178:179], v[22:23] op_sel_hi:[1,0,1]
    s_waitcnt lgkmcnt(2)
    v_pk_add_f32 v[200:201], v[200:201], v[204:205]
    v_pk_add_f32 v[202:203], v[202:203], v[206:207]
    v_pk_fma_f32 v[20:21], v[200:201], v[180:181], v[20:21] op_sel_hi:[1,0,1]
    v_pk_fma_f32 v[22:23], v[202:203], v[180:181], v[22:23] op_sel_hi:[1,0,1]
    s_waitcnt lgkmcnt(0)
    v_pk_add_f32 v[208:209], v[208:209], v[212:213]
    v_pk_add_f32 v[210:211], v[210:211], v[214:215]
    v_pk_fma_f32 v[20:21], v[208:209], v[182:183], v[20:21] op_sel_hi:[1,0,1]
    v_pk_fma_f32 v[22:23], v[210:211], v[182:183], v[22:23] op_sel_hi:[1,0,1]
    v_cndmask_b32 v20, v20, v24, s[68:69]
    v_cndmask_b32 v21, v21, v25, s[68:69]
    v_cndmask_b32 v22, v22, 0, s[68:69]
    v_cndmask_b32 v23, v23, 0, s[68:69]
    v_min_u32 v20, -2, v20
    v_min_u32 v21, -2, v21
    v_min_u32 v22, -2, v22
    v_min_u32 v23, -2, v23
    buffer_store_dwordx4 v[20:23], v220, s[48:51], s64 offen sc1
L_published:
    s_cmp_lt_u32 s6, 5
    s_cbranch_scc1 L_hop1
    s_cmp_eq_u32 s6, 7
    s_cbranch_scc0 L_sdone
    s_cmp_lt_u32 s4, 5
    s_cbranch_scc0 L_sdone
    s_lshl_b32 s8, s4, 15
    s_lshl_b32 s9, s7, 13
    s_add_u32 s8, s8, s9
    s_add_u32 s8, s8, 1048576
    s_add_u32 s9, s8, 4096
    v_mov_b32 v29, 4000
    s_mov_b32 s15, 1600000
L_lw_all:
    ds_read_b32 v30, v29
    s_waitcnt lgkmcnt(0)
    v_cmp_eq_u32 vcc, 0, v30
    s_cbranch_vccz L_lw_all_ok
    s_sub_u32 s15, s15, 1
    s_cmp_lg_u32 s15, 0
    s_cbranch_scc1 L_lw_all
L_lw_all_ok:
    s_mov_b32 s15, 200000
L_poll2:
    buffer_load_dwordx4 v[64:67], v220, s[48:51], s8 offen offset:0 sc1
    buffer_load_dwordx4 v[68:71], v220, s[48:51], s8 offen offset:1024 sc1
    buffer_load_dwordx4 v[72:75], v220, s[48:51], s8 offen offset:2048 sc1
    buffer_load_dwordx4 v[76:79], v220, s[48:51], s8 offen offset:3072 sc1
    buffer_load_dwordx4 v[80:83], v220, s[48:51], s9 offen offset:0 sc1
    buffer_load_dwordx4 v[84:87], v220, s[48:51], s9 offen offset:1024 sc1
    buffer_load_dwordx4 v[88:91], v220, s[48:51], s9 offen offset:2048 sc1
    buffer_load_dwordx4 v[92:95], v220, s[48:51], s9 offen offset:3072 sc1
    s_waitcnt vmcnt(7)
    v_max3_u32 v24, v64, v65, v66
    v_max_u32 v24, v67, v24
    s_waitcnt vmcnt(6)
    v_max3_u32 v24, v68, v69, v24
    v_max3_u32 v24, v70, v71, v24
    s_waitcnt vmcnt(5)
    v_max3_u32 v24, v72, v73, v24
    v_max3_u32 v24, v74, v75, v24
    s_waitcnt vmcnt(4)
    v_max3_u32 v24, v76, v77, v24
    v_max3_u32 v24, v78, v79, v24
    s_waitcnt vmcnt(3)
    v_max3_u32 v24, v80, v81, v24
    v_max3_u32 v24, v82, v83, v24
    s_waitcnt vmcnt(2)
    v_max3_u32 v24, v84, v85, v24
    v_max3_u32 v24, v86, v87, v24
    s_waitcnt vmcnt(1)
    v_max3_u32 v24, v88, v89, v24
    v_max3_u32 v24, v90, v91, v24
    s_waitcnt vmcnt(0)
    v_max3_u32 v24, v92, v93, v24
    v_max3_u32 v24, v94, v95, v24
    v_cmp_eq_u32 vcc, -1, v24
    s_cbranch_vccz L_poll2_ok
    s_sub_u32 s15, s15, 1
    s_cmp_lg_u32 s15, 0
    s_cbranch_scc1 L_poll2
L_poll2_ok:
    v_pk_add_f32 v[64:65], v[64:65], v[80:81]
    v_pk_add_f32 v[66:67], v[66:67], v[82:83]
    v_pk_add_f32 v[68:69], v[68:69], v[84:85]
    v_pk_add_f32 v[70:71], v[70:71], v[86:87]
    v_pk_add_f32 v[72:73], v[72:73], v[88:89]
    v_pk_add_f32 v[74:75], v[74:75], v[90:91]
    v_pk_add_f32 v[76:77], v[76:77], v[92:93]
    v_pk_add_f32 v[78:79], v[78:79], v[94:95]
    v_pk_add_f32 v[64:65], v[64:65], v[72:73]
    v_pk_add_f32 v[66:67], v[66:67], v[74:75]
    v_pk_add_f32 v[68:69], v[68:69], v[76:77]
    v_pk_add_f32 v[70:71], v[70:71], v[78:79]
    v_pk_add_f32 v[64:65], v[64:65], v[68:69]
    v_pk_add_f32 v[66:67], v[66:67], v[70:71]
    ds_write_b128 v223, v[64:67]
    s_waitcnt lgkmcnt(0)
    s_barrier
    s_branch L_sdone
L_hop1:
    buffer_load_dwordx4 v[136:139], v222, s[52:55], s67 offen offset:0 nt
    buffer_load_dwordx4 v[140:143], v222, s[52:55], s67 offen offset:1280 nt
    buffer_load_dwordx4 v[144:147], v222, s[52:55], s67 offen offset:2560 nt
    s_add_u32 s67, s67, 3840
    buffer_load_dwordx4 v[148:151], v222, s[52:55], s67 offen offset:0 nt
    buffer_load_dwordx4 v[152:155], v222, s[52:55], s67 offen offset:1280 nt
    buffer_load_dwordx4 v[156:159], v222, s[52:55], s67 offen offset:2560 nt
    s_waitcnt vmcnt(2)
    s_mov_b32 s15, 200000
L_poll1:
    buffer_load_dwordx4 v[160:163], v221, s[48:51], s65 offen sc1
    buffer_load_dwordx4 v[164:167], v224, s[48:51], s65 offen sc1
    buffer_load_dwordx4 v[168:171], v225, s[48:51], s65 offen sc1
    buffer_load_dwordx4 v[172:175], v226, s[48:51], s65 offen sc1
    s_waitcnt vmcnt(0)
    v_max3_u32 v24, v160, v161, v162
    v_max3_u32 v24, v163, v164, v24
    v_max3_u32 v24, v165, v166, v24
    v_max3_u32 v24, v167, v168, v24
    v_max3_u32 v24, v169, v170, v24
    v_max3_u32 v24, v171, v172, v24
    v_max3_u32 v24, v173, v174, v24
    v_max_u32 v24, v175, v24
    v_cmp_eq_u32 vcc, -1, v24
    s_cbranch_vccz L_poll1_ok
    s_mov_b64 exec, vcc
    s_sub_u32 s15, s15, 1
    s_cmp_lg_u32 s15, 0
    s_cbranch_scc1 L_poll1
L_poll1_ok:
    s_mov_b64 exec, -1
    v_mov_b32_dpp v176, v160 quad_perm:[3,3,3,3] row_mask:0xf bank_mask:0xf
    v_mov_b32_dpp v178, v164 quad_perm:[3,3,3,3] row_mask:0xf bank_mask:0xf
    v_mov_b32_dpp v180, v168 quad_perm:[3,3,3,3] row_mask:0xf bank_mask:0xf
    v_mov_b32_dpp v182, v172 quad_perm:[3,3,3,3] row_mask:0xf bank_mask:0xf
    v_max_f32 v24, v176, v178
    v_max3_f32 v24, v180, v182, v24
    s_nop 1
    v_max_f32_dpp v25, v24, v24 row_shl:4 row_mask:0xf bank_mask:0x5
    v_max_f32_dpp v25, v24, v24 row_shr:4 row_mask:0xf bank_mask:0xa
    v_sub_f32 v176, v176, v25
    v_sub_f32 v178, v178, v25
    v_sub_f32 v180, v180, v25
    v_sub_f32 v182, v182, v25
    v_exp_f32 v176, v176
    v_exp_f32 v178, v178
    v_exp_f32 v180, v180
    v_exp_f32 v182, v182
    s_nop 0
    v_pk_mul_f32 v[184:185], v[160:161], v[176:177] op_sel_hi:[1,0]
    v_pk_mul_f32 v[186:187], v[162:163], v[176:177] op_sel_hi:[1,0]
    v_pk_fma_f32 v[184:185], v[164:165], v[178:179], v[184:185] op_sel_hi:[1,0,1]
    v_pk_fma_f32 v[186:187], v[166:167], v[178:179], v[186:187] op_sel_hi:[1,0,1]
    v_pk_fma_f32 v[184:185], v[168:169], v[180:181], v[184:185] op_sel_hi:[1,0,1]
    v_pk_fma_f32 v[186:187], v[170:171], v[180:181], v[186:187] op_sel_hi:[1,0,1]
    v_pk_fma_f32 v[184:185], v[172:173], v[182:183], v[184:185] op_sel_hi:[1,0,1]
    v_pk_fma_f32 v[186:187], v[174:175], v[182:183], v[186:187] op_sel_hi:[1,0,1]
    s_nop 0
    v_add_f32_dpp v189, v185, v185 row_shl:4 row_mask:0xf bank_mask:0x5
    v_add_f32_dpp v189, v185, v185 row_shr:4 row_mask:0xf bank_mask:0xa
    v_add_f32_dpp v188, v184, v184 row_shl:4 row_mask:0xf bank_mask:0x5
    v_add_f32_dpp v188, v184, v184 row_shr:4 row_mask:0xf bank_mask:0xa
    v_add_f32_dpp v190, v186, v186 row_shl:4 row_mask:0xf bank_mask:0x5
    v_add_f32_dpp v190, v186, v186 row_shr:4 row_mask:0xf bank_mask:0xa
    v_add_f32_dpp v191, v187, v187 row_shl:4 row_mask:0xf bank_mask:0x5
    v_add_f32_dpp v191, v187, v187 row_shr:4 row_mask:0xf bank_mask:0xa
    v_mov_b32_dpp v24, v189 quad_perm:[3,3,3,3] row_mask:0xf bank_mask:0xf
    v_rcp_f32 v24, v24
    s_nop 0
    v_pk_mul_f32 v[188:189], v[188:189], v[24:25] op_sel_hi:[1,0]
    v_pk_mul_f32 v[190:191], v[190:191], v[24:25] op_sel_hi:[1,0]
    v_cvt_pk_bf16_f32 v188, v188, v188
    v_cvt_pk_bf16_f32 v189, v189, v189
    v_cvt_pk_bf16_f32 v190, v190, v190
    v_cvt_pk_bf16_f32 v191, v191, v191
    v_and_b32_dpp v64, v188, v4 quad_perm:[0,0,0,0] row_mask:0xf bank_mask:0xf
    v_and_b32_dpp v65, v188, v5 quad_perm:[0,0,0,0] row_mask:0xf bank_mask:0xf
    v_and_b32_dpp v66, v188, v6 quad_perm:[0,0,0,0] row_mask:0xf bank_mask:0xf
    v_and_b32_dpp v67, v188, v7 quad_perm:[0,0,0,0] row_mask:0xf bank_mask:0xf
    v_and_b32_dpp v68, v189, v4 quad_perm:[0,0,0,0] row_mask:0xf bank_mask:0xf
    v_and_b32_dpp v69, v189, v5 quad_perm:[0,0,0,0] row_mask:0xf bank_mask:0xf
    v_and_b32_dpp v70, v189, v6 quad_perm:[0,0,0,0] row_mask:0xf bank_mask:0xf
    v_and_b32_dpp v71, v189, v7 quad_perm:[0,0,0,0] row_mask:0xf bank_mask:0xf
    v_mfma_f32_16x16x32_bf16 v[20:23], v[64:67], v[112:115], 0
    v_and_b32_dpp v72, v190, v4 quad_perm:[0,0,0,0] row_mask:0xf bank_mask:0xf
    v_and_b32_dpp v73, v190, v5 quad_perm:[0,0,0,0] row_mask:0xf bank_mask:0xf
    v_and_b32_dpp v74, v190, v6 quad_perm:[0,0,0,0] row_mask:0xf bank_mask:0xf
    v_and_b32_dpp v75, v190, v7 quad_perm:[0,0,0,0] row_mask:0xf bank_mask:0xf
    v_mfma_f32_16x16x32_bf16 v[20:23], v[68:71], v[116:119], v[20:23]
    v_and_b32_dpp v76, v191, v4 quad_perm:[0,0,0,0] row_mask:0xf bank_mask:0xf
    v_and_b32_dpp v77, v191, v5 quad_perm:[0,0,0,0] row_mask:0xf bank_mask:0xf
    v_and_b32_dpp v78, v191, v6 quad_perm:[0,0,0,0] row_mask:0xf bank_mask:0xf
    v_and_b32_dpp v79, v191, v7 quad_perm:[0,0,0,0] row_mask:0xf bank_mask:0xf
    v_mfma_f32_16x16x32_bf16 v[20:23], v[72:75], v[120:123], v[20:23]
    v_and_b32_dpp v80, v188, v4 quad_perm:[1,1,1,1] row_mask:0xf bank_mask:0xf
    v_and_b32_dpp v81, v188, v5 quad_perm:[1,1,1,1] row_mask:0xf bank_mask:0xf
    v_and_b32_dpp v82, v188, v6 quad_perm:[1,1,1,1] row_mask:0xf bank_mask:0xf
    v_and_b32_dpp v83, v188, v7 quad_perm:[1,1,1,1] row_mask:0xf bank_mask:0xf
    v_mfma_f32_16x16x32_bf16 v[20:23], v[76:79], v[124:127], v[20:23]
    v_and_b32_dpp v84, v189, v4 quad_perm:[1,1,1,1] row_mask:0xf bank_mask:0xf
    v_and_b32_dpp v85, v189, v5 quad_perm:[1,1,1,1] row_mask:0xf bank_mask:0xf
    v_and_b32_dpp v86, v189, v6 quad_perm:[1,1,1,1] row_mask:0xf bank_mask:0xf
    v_and_b32_dpp v87, v189, v7 quad_perm:[1,1,1,1] row_mask:0xf bank_mask:0xf
    v_mfma_f32_16x16x32_bf16 v[20:23], v[80:83], v[128:131], v[20:23]
    v_and_b32_dpp v88, v190, v4 quad_perm:[1,1,1,1] row_mask:0xf bank_mask:0xf
    v_and_b32_dpp v89, v190, v5 quad_perm:[1,1,1,1] row_mask:0xf bank_mask:0xf
    v_and_b32_dpp v90, v190, v6 quad_perm:[1,1,1,1] row_mask:0xf bank_mask:0xf
    v_and_b32_dpp v91, v190, v7 quad_perm:[1,1,1,1] row_mask:0xf bank_mask:0xf
    v_mfma_f32_16x16x32_bf16 v[20:23], v[84:87], v[132:135], v[20:23]
    v_and_b32_dpp v92, v191, v4 quad_perm:[1,1,1,1] row_mask:0xf bank_mask:0xf
    v_and_b32_dpp v93, v191, v5 quad_perm:[1,1,1,1] row_mask:0xf bank_mask:0xf
    v_and_b32_dpp v94, v191, v6 quad_perm:[1,1,1,1] row_mask:0xf bank_mask:0xf
    v_and_b32_dpp v95, v191, v7 quad_perm:[1,1,1,1] row_mask:0xf bank_mask:0xf
    v_mfma_f32_16x16x32_bf16 v[20:23], v[88:91], v[136:139], v[20:23]
    v_and_b32_dpp v96, v188, v4 quad_perm:[2,2,2,2] row_mask:0xf bank_mask:0xf
    v_and_b32_dpp v97, v188, v5 quad_perm:[2,2,2,2] row_mask:0xf bank_mask:0xf
    v_and_b32_dpp v98, v188, v6 quad_perm:[2,2,2,2] row_mask:0xf bank_mask:0xf
    v_and_b32_dpp v99, v188, v7 quad_perm:[2,2,2,2] row_mask:0xf bank_mask:0xf
    v_mfma_f32_16x16x32_bf16 v[20:23], v[92:95], v[140:143], v[20:23]
    v_and_b32_dpp v100, v189, v4 quad_perm:[2,2,2,2] row_mask:0xf bank_mask:0xf
    v_and_b32_dpp v101, v189, v5 quad_perm:[2,2,2,2] row_mask:0xf bank_mask:0xf
    v_and_b32_dpp v102, v189, v6 quad_perm:[2,2,2,2] row_mask:0xf bank_mask:0xf
    v_and_b32_dpp v103, v189, v7 quad_perm:[2,2,2,2] row_mask:0xf bank_mask:0xf
    v_mfma_f32_16x16x32_bf16 v[20:23], v[96:99], v[144:147], v[20:23]
    v_and_b32_dpp v104, v190, v4 quad_perm:[2,2,2,2] row_mask:0xf bank_mask:0xf
    v_and_b32_dpp v105, v190, v5 quad_perm:[2,2,2,2] row_mask:0xf bank_mask:0xf
    v_and_b32_dpp v106, v190, v6 quad_perm:[2,2,2,2] row_mask:0xf bank_mask:0xf
    v_and_b32_dpp v107, v190, v7 quad_perm:[2,2,2,2] row_mask:0xf bank_mask:0xf
    v_mfma_f32_16x16x32_bf16 v[20:23], v[100:103], v[148:151], v[20:23]
    v_and_b32_dpp v108, v191, v4 quad_perm:[2,2,2,2] row_mask:0xf bank_mask:0xf
    v_and_b32_dpp v109, v191, v5 quad_perm:[2,2,2,2] row_mask:0xf bank_mask:0xf
    v_and_b32_dpp v110, v191, v6 quad_perm:[2,2,2,2] row_mask:0xf bank_mask:0xf
    v_and_b32_dpp v111, v191, v7 quad_perm:[2,2,2,2] row_mask:0xf bank_mask:0xf
    v_mfma_f32_16x16x32_bf16 v[20:23], v[104:107], v[152:155], v[20:23]
    s_nop 1
    v_mfma_f32_16x16x32_bf16 v[20:23], v[108:111], v[156:159], v[20:23]
    s_nop 7
    ds_write_b128 v223, v[20:23]
    s_waitcnt lgkmcnt(0)
    s_barrier
    s_cmp_eq_u32 s7, 0
    s_cbranch_scc0 L_sdone
    ds_read_b128 v[64:67], v220 offset:16384
    ds_read_b128 v[68:71], v220 offset:17408
    ds_read_b128 v[72:75], v220 offset:18432
    ds_read_b128 v[76:79], v220 offset:19456
    s_waitcnt lgkmcnt(2)
    v_pk_add_f32 v[64:65], v[64:65], v[68:69]
    v_pk_add_f32 v[66:67], v[66:67], v[70:71]
    s_waitcnt lgkmcnt(0)
    v_pk_add_f32 v[72:73], v[72:73], v[76:77]
    v_pk_add_f32 v[74:75], v[74:75], v[78:79]
    v_pk_add_f32 v[64:65], v[64:65], v[72:73]
    v_pk_add_f32 v[66:67], v[66:67], v[74:75]
    v_min_u32 v64, -2, v64
    v_min_u32 v65, -2, v65
    v_min_u32 v66, -2, v66
    v_min_u32 v67, -2, v67
    buffer_store_dwordx4 v[64:67], v220, s[48:51], s66 offen sc1
L_sdone:
    s_endpgm
.p2align 3
L_nonstream:
    s_cmp_eq_u32 s6, 7
    s_cselect_b32 s101, 1, 0
    s_cmp_lt_u32 s4, 5
    s_cselect_b32 s101, s101, 0
    s_cmp_eq_u32 s3, 4
    s_cbranch_scc0 L_ffnw
    s_setprio 3
    v_mul_u32_u24 v108, 20, v1
    v_lshrrev_b32 v36, 3, v1
    v_mul_u32_u24 v109, 122880, v36
    v_and_b32 v37, 7, v1
    v_lshl_add_u32 v109, v37, 4, v109
    s_mul_i32 s8, s5, 983040
    s_mul_i32 s9, s4, 384
    s_add_u32 s12, s8, s9
    v_lshlrev_b32 v110, 4, v1
    v_mov_b32 v44, 0
    v_mov_b32 v45, 0
    v_lshlrev_b32 v46, 3, v1
    v_min_u32 v47, 312, v46
    ds_write_b64 v47, v[44:45] offset:3328
    v_min_u32 v47, 56, v46
    ds_write_b64 v47, v[44:45] offset:3968
    s_mul_i32 s10, s2, 1536
    s_waitcnt lgkmcnt(0)
    s_mov_b32 s68, s16
    s_and_b32 s69, s17, 0xffff
    s_mov_b32 s70, 2560
    s_mov_b32 s71, 0x20000
    s_mov_b32 s52, s22
    s_and_b32 s53, s23, 0xffff
    s_mov_b32 s54, 7864320
    s_mov_b32 s55, 0x20000
    buffer_load_dwordx4 v[2:5], v108, s[68:71], 0 offen
    buffer_load_dword v6, v108, s[68:71], 0 offen offset:16
    buffer_load_dwordx4 v[8:11], v108, s[68:71], 0 offen offset:1280
    buffer_load_dword v12, v108, s[68:71], 0 offen offset:1296
    buffer_load_dwordx4 v[128:131], v109, s[52:55], s12 offen offset:0 nt
    buffer_load_dwordx4 v[132:135], v109, s[52:55], s12 offen offset:128 nt
    buffer_load_dwordx4 v[136:139], v109, s[52:55], s12 offen offset:256 nt
    s_add_u32 s12, s12, 12288
    buffer_load_dwordx4 v[140:143], v109, s[52:55], s12 offen offset:0 nt
    buffer_load_dwordx4 v[144:147], v109, s[52:55], s12 offen offset:128 nt
    buffer_load_dwordx4 v[148:151], v109, s[52:55], s12 offen offset:256 nt
    s_add_u32 s12, s12, 12288
    buffer_load_dwordx4 v[152:155], v109, s[52:55], s12 offen offset:0 nt
    buffer_load_dwordx4 v[156:159], v109, s[52:55], s12 offen offset:128 nt
    buffer_load_dwordx4 v[160:163], v109, s[52:55], s12 offen offset:256 nt
    s_add_u32 s12, s12, 12288
    buffer_load_dwordx4 v[164:167], v109, s[52:55], s12 offen offset:0 nt
    buffer_load_dwordx4 v[168:171], v109, s[52:55], s12 offen offset:128 nt
    buffer_load_dwordx4 v[172:175], v109, s[52:55], s12 offen offset:256 nt
    s_add_u32 s12, s12, 12288
    buffer_load_dwordx4 v[176:179], v109, s[52:55], s12 offen offset:0 nt
    buffer_load_dwordx4 v[180:183], v109, s[52:55], s12 offen offset:128 nt
    buffer_load_dwordx4 v[184:187], v109, s[52:55], s12 offen offset:256 nt
    s_add_u32 s12, s12, 12288
    buffer_load_dwordx4 v[188:191], v109, s[52:55], s12 offen offset:0 nt
    buffer_load_dwordx4 v[192:195], v109, s[52:55], s12 offen offset:128 nt
    buffer_load_dwordx4 v[196:199], v109, s[52:55], s12 offen offset:256 nt
    s_add_u32 s12, s12, 12288
    buffer_load_dwordx4 v[200:203], v109, s[52:55], s12 offen offset:0 nt
    buffer_load_dwordx4 v[204:207], v109, s[52:55], s12 offen offset:128 nt
    buffer_load_dwordx4 v[208:211], v109, s[52:55], s12 offen offset:256 nt
    s_add_u32 s12, s12, 12288
    buffer_load_dwordx4 v[212:215], v109, s[52:55], s12 offen offset:0 nt
    buffer_load_dwordx4 v[216:219], v109, s[52:55], s12 offen offset:128 nt
    buffer_load_dwordx4 v[220:223], v109, s[52:55], s12 offen offset:256 nt
    s_add_u32 s12, s12, 12288
    buffer_load_dwordx4 v[224:227], v109, s[52:55], s12 offen offset:0 nt
    buffer_load_dwordx4 v[228:231], v109, s[52:55], s12 offen offset:128 nt
    buffer_load_dwordx4 v[232:235], v109, s[52:55], s12 offen offset:256 nt
    s_add_u32 s12, s12, 12288
    buffer_load_dwordx4 v[236:239], v109, s[52:55], s12 offen offset:0 nt
    buffer_load_dwordx4 v[240:243], v109, s[52:55], s12 offen offset:128 nt
    buffer_load_dwordx4 v[244:247], v109, s[52:55], s12 offen offset:256 nt
    s_barrier
    s_mov_b32 s64, s36
    s_and_b32 s65, s37, 0xffff
    s_mov_b32 s66, 256
    s_mov_b32 s67, 0x20000
    s_mov_b32 s48, s38
    s_and_b32 s49, s39, 0xffff
    s_mov_b32 s50, 2097152
    s_mov_b32 s51, 0x20000
    v_and_b32 v44, 1, v1
    v_cmp_eq_u32 vcc, 1, v44
    v_mov_b32 v44, 0x0c0c0100
    v_mov_b32 v45, 0x01000c0c
    v_cndmask_b32 v44, v44, v45, vcc
    v_mov_b32 v45, 0x0c0c0302
    v_mov_b32 v46, 0x03020c0c
    v_cndmask_b32 v45, v45, v46, vcc
    v_mov_b32 v46, 0x0c0c0c0c
    v_bfe_u32 v47, v1, 1, 2
    v_cmp_eq_u32 vcc, 0, v47
    s_nop 1
    v_cndmask_b32 v48, v46, v44, vcc
    v_cndmask_b32 v52, v46, v45, vcc
    v_cmp_eq_u32 vcc, 1, v47
    s_nop 1
    v_cndmask_b32 v49, v46, v44, vcc
    v_cndmask_b32 v53, v46, v45, vcc
    v_cmp_eq_u32 vcc, 2, v47
    s_nop 1
    v_cndmask_b32 v50, v46, v44, vcc
    v_cndmask_b32 v54, v46, v45, vcc
    v_cmp_eq_u32 vcc, 3, v47
    s_nop 1
    v_cndmask_b32 v51, v46, v44, vcc
    v_cndmask_b32 v55, v46, v45, vcc
    s_waitcnt vmcnt(30)
    v_lshlrev_b32 v16, 16, v2
    v_and_b32 v17, 0xffff0000, v2
    v_lshlrev_b32 v18, 16, v3
    v_and_b32 v19, 0xffff0000, v3
    v_lshlrev_b32 v20, 16, v4
    v_and_b32 v21, 0xffff0000, v4
    v_lshlrev_b32 v22, 16, v5
    v_and_b32 v23, 0xffff0000, v5
    v_lshlrev_b32 v24, 16, v6
    v_and_b32 v25, 0xffff0000, v6
    v_lshlrev_b32 v26, 16, v8
    v_and_b32 v27, 0xffff0000, v8
    v_lshlrev_b32 v28, 16, v9
    v_and_b32 v29, 0xffff0000, v9
    v_lshlrev_b32 v30, 16, v10
    v_and_b32 v31, 0xffff0000, v10
    v_lshlrev_b32 v32, 16, v11
    v_and_b32 v33, 0xffff0000, v11
    v_lshlrev_b32 v34, 16, v12
    v_and_b32 v35, 0xffff0000, v12
    v_add_f32 v36, v16, v17
    v_add_f32 v37, v26, v27
    v_add_f32 v36, v36, v18
    v_add_f32 v37, v37, v28
    v_add_f32 v36, v36, v19
    v_add_f32 v37, v37, v29
    v_add_f32 v36, v36, v20
    v_add_f32 v37, v37, v30
    v_add_f32 v36, v36, v21
    v_add_f32 v37, v37, v31
    v_add_f32 v36, v36, v22
    v_add_f32 v37, v37, v32
    v_add_f32 v36, v36, v23
    v_add_f32 v37, v37, v33
    v_add_f32 v36, v36, v24
    v_add_f32 v37, v37, v34
    v_add_f32 v36, v36, v25
    v_add_f32 v37, v37, v35
    s_nop 0
    s_nop 0
    v_add_f32_dpp v36, v36, v36 quad_perm:[1,0,3,2] row_mask:0xf bank_mask:0xf
    v_add_f32_dpp v37, v37, v37 quad_perm:[1,0,3,2] row_mask:0xf bank_mask:0xf
    s_nop 0
    v_add_f32_dpp v36, v36, v36 quad_perm:[2,3,0,1] row_mask:0xf bank_mask:0xf
    v_add_f32_dpp v37, v37, v37 quad_perm:[2,3,0,1] row_mask:0xf bank_mask:0xf
    s_nop 0
    v_add_f32_dpp v36, v36, v36 row_half_mirror row_mask:0xf bank_mask:0xf
    v_add_f32_dpp v37, v37, v37 row_half_mirror row_mask:0xf bank_mask:0xf
    s_nop 0
    v_add_f32_dpp v36, v36, v36 row_mirror row_mask:0xf bank_mask:0xf
    v_add_f32_dpp v37, v37, v37 row_mirror row_mask:0xf bank_mask:0xf
    v_mov_b32 v38, v36
    v_mov_b32 v39, v37
    s_nop 0
    v_permlane16_swap_b32 v36, v38
    v_permlane16_swap_b32 v37, v39
    s_nop 0
    v_add_f32 v36, v36, v38
    v_add_f32 v37, v37, v39
    v_mov_b32 v38, v36
    v_mov_b32 v39, v37
    s_nop 0
    v_permlane32_swap_b32 v36, v38
    v_permlane32_swap_b32 v37, v39
    s_nop 0
    v_add_f32 v36, v36, v38
    v_add_f32 v37, v37, v39
    v_mul_f32 v36, 0x3acccccd, v36
    v_mul_f32 v37, 0x3acccccd, v37
    v_sub_f32 v42, v16, v36
    v_sub_f32 v43, v26, v37
    v_mul_f32 v40, v42, v42
    v_mul_f32 v41, v43, v43
    v_sub_f32 v42, v17, v36
    v_sub_f32 v43, v27, v37
    v_fmac_f32 v40, v42, v42
    v_fmac_f32 v41, v43, v43
    v_sub_f32 v42, v18, v36
    v_sub_f32 v43, v28, v37
    v_fmac_f32 v40, v42, v42
    v_fmac_f32 v41, v43, v43
    v_sub_f32 v42, v19, v36
    v_sub_f32 v43, v29, v37
    v_fmac_f32 v40, v42, v42
    v_fmac_f32 v41, v43, v43
    v_sub_f32 v42, v20, v36
    v_sub_f32 v43, v30, v37
    v_fmac_f32 v40, v42, v42
    v_fmac_f32 v41, v43, v43
    v_sub_f32 v42, v21, v36
    v_sub_f32 v43, v31, v37
    v_fmac_f32 v40, v42, v42
    v_fmac_f32 v41, v43, v43
    v_sub_f32 v42, v22, v36
    v_sub_f32 v43, v32, v37
    v_fmac_f32 v40, v42, v42
    v_fmac_f32 v41, v43, v43
    v_sub_f32 v42, v23, v36
    v_sub_f32 v43, v33, v37
    v_fmac_f32 v40, v42, v42
    v_fmac_f32 v41, v43, v43
    v_sub_f32 v42, v24, v36
    v_sub_f32 v43, v34, v37
    v_fmac_f32 v40, v42, v42
    v_fmac_f32 v41, v43, v43
    v_sub_f32 v42, v25, v36
    v_sub_f32 v43, v35, v37
    v_fmac_f32 v40, v42, v42
    v_fmac_f32 v41, v43, v43
    s_nop 0
    s_nop 0
    v_add_f32_dpp v40, v40, v40 quad_perm:[1,0,3,2] row_mask:0xf bank_mask:0xf
    v_add_f32_dpp v41, v41, v41 quad_perm:[1,0,3,2] row_mask:0xf bank_mask:0xf
    s_nop 0
    v_add_f32_dpp v40, v40, v40 quad_perm:[2,3,0,1] row_mask:0xf bank_mask:0xf
    v_add_f32_dpp v41, v41, v41 quad_perm:[2,3,0,1] row_mask:0xf bank_mask:0xf
    s_nop 0
    v_add_f32_dpp v40, v40, v40 row_half_mirror row_mask:0xf bank_mask:0xf
    v_add_f32_dpp v41, v41, v41 row_half_mirror row_mask:0xf bank_mask:0xf
    s_nop 0
    v_add_f32_dpp v40, v40, v40 row_mirror row_mask:0xf bank_mask:0xf
    v_add_f32_dpp v41, v41, v41 row_mirror row_mask:0xf bank_mask:0xf
    v_mov_b32 v38, v40
    v_mov_b32 v39, v41
    s_nop 0
    v_permlane16_swap_b32 v40, v38
    v_permlane16_swap_b32 v41, v39
    s_nop 0
    v_add_f32 v40, v40, v38
    v_add_f32 v41, v41, v39
    v_mov_b32 v38, v40
    v_mov_b32 v39, v41
    s_nop 0
    v_permlane32_swap_b32 v40, v38
    v_permlane32_swap_b32 v41, v39
    s_nop 0
    v_add_f32 v40, v40, v38
    v_add_f32 v41, v41, v39
    v_mul_f32 v40, 0x3acccccd, v40
    v_cvt_pk_bf16_f32 v36, 0, v36
    v_mul_f32 v41, 0x3acccccd, v41
    v_cvt_pk_bf16_f32 v37, 0, v37
    v_cvt_pk_bf16_f32 v40, 0, v40
    v_cvt_pk_bf16_f32 v41, 0, v41
    v_add_f32 v40, 0x3727c5ac, v40
    v_add_f32 v41, 0x3727c5ac, v41
    v_cvt_pk_bf16_f32 v40, 0, v40
    v_cvt_pk_bf16_f32 v41, 0, v41
    v_sqrt_f32 v40, v40
    v_sqrt_f32 v41, v41
    s_nop 0
    v_cvt_pk_bf16_f32 v40, 0, v40
    v_cvt_pk_bf16_f32 v41, 0, v41
    v_rcp_f32 v40, v40
    v_rcp_f32 v41, v41
    v_sub_f32 v16, v16, v36
    v_sub_f32 v17, v17, v36
    v_sub_f32 v18, v18, v36
    v_sub_f32 v19, v19, v36
    v_sub_f32 v20, v20, v36
    v_sub_f32 v21, v21, v36
    v_sub_f32 v22, v22, v36
    v_sub_f32 v23, v23, v36
    v_sub_f32 v24, v24, v36
    v_sub_f32 v25, v25, v36
    v_sub_f32 v26, v26, v37
    v_sub_f32 v27, v27, v37
    v_sub_f32 v28, v28, v37
    v_sub_f32 v29, v29, v37
    v_sub_f32 v30, v30, v37
    v_sub_f32 v31, v31, v37
    v_sub_f32 v32, v32, v37
    v_sub_f32 v33, v33, v37
    v_sub_f32 v34, v34, v37
    v_sub_f32 v35, v35, v37
    v_cvt_pk_bf16_f32 v16, 0, v16
    v_cvt_pk_bf16_f32 v17, 0, v17
    v_cvt_pk_bf16_f32 v18, 0, v18
    v_cvt_pk_bf16_f32 v19, 0, v19
    v_cvt_pk_bf16_f32 v20, 0, v20
    v_cvt_pk_bf16_f32 v21, 0, v21
    v_cvt_pk_bf16_f32 v22, 0, v22
    v_cvt_pk_bf16_f32 v23, 0, v23
    v_cvt_pk_bf16_f32 v24, 0, v24
    v_cvt_pk_bf16_f32 v25, 0, v25
    v_cvt_pk_bf16_f32 v26, 0, v26
    v_cvt_pk_bf16_f32 v27, 0, v27
    v_cvt_pk_bf16_f32 v28, 0, v28
    v_cvt_pk_bf16_f32 v29, 0, v29
    v_cvt_pk_bf16_f32 v30, 0, v30
    v_cvt_pk_bf16_f32 v31, 0, v31
    v_cvt_pk_bf16_f32 v32, 0, v32
    v_cvt_pk_bf16_f32 v33, 0, v33
    v_cvt_pk_bf16_f32 v34, 0, v34
    v_cvt_pk_bf16_f32 v35, 0, v35
    v_mul_f32 v16, v16, v40
    v_mul_f32 v17, v17, v40
    v_mul_f32 v18, v18, v40
    v_mul_f32 v19, v19, v40
    v_mul_f32 v20, v20, v40
    v_mul_f32 v21, v21, v40
    v_mul_f32 v22, v22, v40
    v_mul_f32 v23, v23, v40
    v_mul_f32 v24, v24, v40
    v_mul_f32 v25, v25, v40
    v_mul_f32 v26, v26, v41
    v_mul_f32 v27, v27, v41
    v_mul_f32 v28, v28, v41
    v_mul_f32 v29, v29, v41
    v_mul_f32 v30, v30, v41
    v_mul_f32 v31, v31, v41
    v_mul_f32 v32, v32, v41
    v_mul_f32 v33, v33, v41
    v_mul_f32 v34, v34, v41
    v_mul_f32 v35, v35, v41
    v_cvt_pk_bf16_f32 v2, v16, v17
    v_cvt_pk_bf16_f32 v3, v18, v19
    v_cvt_pk_bf16_f32 v4, v20, v21
    v_cvt_pk_bf16_f32 v5, v22, v23
    v_cvt_pk_bf16_f32 v6, v24, v25
    v_cvt_pk_bf16_f32 v8, v26, v27
    v_cvt_pk_bf16_f32 v9, v28, v29
    v_cvt_pk_bf16_f32 v10, v30, v31
    v_cvt_pk_bf16_f32 v11, v32, v33
    v_cvt_pk_bf16_f32 v12, v34, v35
    v_add_u32 v37, 1280, v108
    ds_write2_b32 v108, v2, v3 offset0:0 offset1:1
    ds_write2_b32 v108, v4, v5 offset0:2 offset1:3
    ds_write_b32 v108, v6 offset:16
    ds_write2_b32 v37, v8, v9 offset0:0 offset1:1
    ds_write2_b32 v37, v10, v11 offset0:2 offset1:3
    ds_write_b32 v37, v12 offset:16
    v_lshrrev_b32 v36, 3, v1
    v_mul_u32_u24 v36, 20, v36
    s_mul_i32 s8, s5, 160
    v_add_u32 v36, s8, v36
    s_waitcnt lgkmcnt(0)
    ds_read_b32 v56, v36 offset:0
    ds_read_b32 v57, v36 offset:4
    ds_read_b32 v58, v36 offset:8
    ds_read_b32 v59, v36 offset:12
    ds_read_b32 v60, v36 offset:16
    ds_read_b32 v62, v36 offset:1280
    ds_read_b32 v63, v36 offset:1284
    ds_read_b32 v64, v36 offset:1288
    ds_read_b32 v65, v36 offset:1292
    ds_read_b32 v66, v36 offset:1296
    s_waitcnt lgkmcnt(0)
    v_perm_b32 v68, v56, v56, v48
    v_perm_b32 v69, v56, v56, v49
    v_perm_b32 v70, v56, v56, v50
    v_perm_b32 v71, v56, v56, v51
    v_perm_b32 v72, v62, v62, v48
    v_perm_b32 v73, v62, v62, v49
    v_perm_b32 v74, v62, v62, v50
    v_perm_b32 v75, v62, v62, v51
    s_waitcnt vmcnt(27)
    s_nop 0
    v_mfma_f32_16x16x32_bf16 v[84:87], v[68:71], v[128:131], 0
    v_mfma_f32_16x16x32_bf16 v[88:91], v[72:75], v[128:131], 0
    v_mfma_f32_16x16x32_bf16 v[92:95], v[68:71], v[132:135], 0
    v_mfma_f32_16x16x32_bf16 v[96:99], v[72:75], v[132:135], 0
    v_mfma_f32_16x16x32_bf16 v[100:103], v[68:71], v[136:139], 0
    v_mfma_f32_16x16x32_bf16 v[104:107], v[72:75], v[136:139], 0
    v_perm_b32 v76, v56, v56, v52
    v_perm_b32 v77, v56, v56, v53
    v_perm_b32 v78, v56, v56, v54
    v_perm_b32 v79, v56, v56, v55
    v_perm_b32 v80, v62, v62, v52
    v_perm_b32 v81, v62, v62, v53
    v_perm_b32 v82, v62, v62, v54
    v_perm_b32 v83, v62, v62, v55
    s_waitcnt vmcnt(24)
    s_nop 0
    v_mfma_f32_16x16x32_bf16 v[84:87], v[76:79], v[140:143], v[84:87]
    v_mfma_f32_16x16x32_bf16 v[88:91], v[80:83], v[140:143], v[88:91]
    v_mfma_f32_16x16x32_bf16 v[92:95], v[76:79], v[144:147], v[92:95]
    v_mfma_f32_16x16x32_bf16 v[96:99], v[80:83], v[144:147], v[96:99]
    v_mfma_f32_16x16x32_bf16 v[100:103], v[76:79], v[148:151], v[100:103]
    v_mfma_f32_16x16x32_bf16 v[104:107], v[80:83], v[148:151], v[104:107]
    v_perm_b32 v68, v57, v57, v48
    v_perm_b32 v69, v57, v57, v49
    v_perm_b32 v70, v57, v57, v50
    v_perm_b32 v71, v57, v57, v51
    v_perm_b32 v72, v63, v63, v48
    v_perm_b32 v73, v63, v63, v49
    v_perm_b32 v74, v63, v63, v50
    v_perm_b32 v75, v63, v63, v51
    s_waitcnt vmcnt(21)
    s_nop 0
    v_mfma_f32_16x16x32_bf16 v[84:87], v[68:71], v[152:155], v[84:87]
    v_mfma_f32_16x16x32_bf16 v[88:91], v[72:75], v[152:155], v[88:91]
    v_mfma_f32_16x16x32_bf16 v[92:95], v[68:71], v[156:159], v[92:95]
    v_mfma_f32_16x16x32_bf16 v[96:99], v[72:75], v[156:159], v[96:99]
    v_mfma_f32_16x16x32_bf16 v[100:103], v[68:71], v[160:163], v[100:103]
    v_mfma_f32_16x16x32_bf16 v[104:107], v[72:75], v[160:163], v[104:107]
    v_perm_b32 v76, v57, v57, v52
    v_perm_b32 v77, v57, v57, v53
    v_perm_b32 v78, v57, v57, v54
    v_perm_b32 v79, v57, v57, v55
    v_perm_b32 v80, v63, v63, v52
    v_perm_b32 v81, v63, v63, v53
    v_perm_b32 v82, v63, v63, v54
    v_perm_b32 v83, v63, v63, v55
    s_waitcnt vmcnt(18)
    s_nop 0
    v_mfma_f32_16x16x32_bf16 v[84:87], v[76:79], v[164:167], v[84:87]
    v_mfma_f32_16x16x32_bf16 v[88:91], v[80:83], v[164:167], v[88:91]
    v_mfma_f32_16x16x32_bf16 v[92:95], v[76:79], v[168:171], v[92:95]
    v_mfma_f32_16x16x32_bf16 v[96:99], v[80:83], v[168:171], v[96:99]
    v_mfma_f32_16x16x32_bf16 v[100:103], v[76:79], v[172:175], v[100:103]
    v_mfma_f32_16x16x32_bf16 v[104:107], v[80:83], v[172:175], v[104:107]
    v_perm_b32 v68, v58, v58, v48
    v_perm_b32 v69, v58, v58, v49
    v_perm_b32 v70, v58, v58, v50
    v_perm_b32 v71, v58, v58, v51
    v_perm_b32 v72, v64, v64, v48
    v_perm_b32 v73, v64, v64, v49
    v_perm_b32 v74, v64, v64, v50
    v_perm_b32 v75, v64, v64, v51
    s_waitcnt vmcnt(15)
    s_nop 0
    v_mfma_f32_16x16x32_bf16 v[84:87], v[68:71], v[176:179], v[84:87]
    v_mfma_f32_16x16x32_bf16 v[88:91], v[72:75], v[176:179], v[88:91]
    v_mfma_f32_16x16x32_bf16 v[92:95], v[68:71], v[180:183], v[92:95]
    v_mfma_f32_16x16x32_bf16 v[96:99], v[72:75], v[180:183], v[96:99]
    v_mfma_f32_16x16x32_bf16 v[100:103], v[68:71], v[184:187], v[100:103]
    v_mfma_f32_16x16x32_bf16 v[104:107], v[72:75], v[184:187], v[104:107]
    v_perm_b32 v76, v58, v58, v52
    v_perm_b32 v77, v58, v58, v53
    v_perm_b32 v78, v58, v58, v54
    v_perm_b32 v79, v58, v58, v55
    v_perm_b32 v80, v64, v64, v52
    v_perm_b32 v81, v64, v64, v53
    v_perm_b32 v82, v64, v64, v54
    v_perm_b32 v83, v64, v64, v55
    s_waitcnt vmcnt(12)
    s_nop 0
    v_mfma_f32_16x16x32_bf16 v[84:87], v[76:79], v[188:191], v[84:87]
    v_mfma_f32_16x16x32_bf16 v[88:91], v[80:83], v[188:191], v[88:91]
    v_mfma_f32_16x16x32_bf16 v[92:95], v[76:79], v[192:195], v[92:95]
    v_mfma_f32_16x16x32_bf16 v[96:99], v[80:83], v[192:195], v[96:99]
    v_mfma_f32_16x16x32_bf16 v[100:103], v[76:79], v[196:199], v[100:103]
    v_mfma_f32_16x16x32_bf16 v[104:107], v[80:83], v[196:199], v[104:107]
    v_perm_b32 v68, v59, v59, v48
    v_perm_b32 v69, v59, v59, v49
    v_perm_b32 v70, v59, v59, v50
    v_perm_b32 v71, v59, v59, v51
    v_perm_b32 v72, v65, v65, v48
    v_perm_b32 v73, v65, v65, v49
    v_perm_b32 v74, v65, v65, v50
    v_perm_b32 v75, v65, v65, v51
    s_waitcnt vmcnt(9)
    s_nop 0
    v_mfma_f32_16x16x32_bf16 v[84:87], v[68:71], v[200:203], v[84:87]
    v_mfma_f32_16x16x32_bf16 v[88:91], v[72:75], v[200:203], v[88:91]
    v_mfma_f32_16x16x32_bf16 v[92:95], v[68:71], v[204:207], v[92:95]
    v_mfma_f32_16x16x32_bf16 v[96:99], v[72:75], v[204:207], v[96:99]
    v_mfma_f32_16x16x32_bf16 v[100:103], v[68:71], v[208:211], v[100:103]
    v_mfma_f32_16x16x32_bf16 v[104:107], v[72:75], v[208:211], v[104:107]
    v_perm_b32 v76, v59, v59, v52
    v_perm_b32 v77, v59, v59, v53
    v_perm_b32 v78, v59, v59, v54
    v_perm_b32 v79, v59, v59, v55
    v_perm_b32 v80, v65, v65, v52
    v_perm_b32 v81, v65, v65, v53
    v_perm_b32 v82, v65, v65, v54
    v_perm_b32 v83, v65, v65, v55
    s_waitcnt vmcnt(6)
    s_nop 0
    v_mfma_f32_16x16x32_bf16 v[84:87], v[76:79], v[212:215], v[84:87]
    v_mfma_f32_16x16x32_bf16 v[88:91], v[80:83], v[212:215], v[88:91]
    v_mfma_f32_16x16x32_bf16 v[92:95], v[76:79], v[216:219], v[92:95]
    v_mfma_f32_16x16x32_bf16 v[96:99], v[80:83], v[216:219], v[96:99]
    v_mfma_f32_16x16x32_bf16 v[100:103], v[76:79], v[220:223], v[100:103]
    v_mfma_f32_16x16x32_bf16 v[104:107], v[80:83], v[220:223], v[104:107]
    v_perm_b32 v68, v60, v60, v48
    v_perm_b32 v69, v60, v60, v49
    v_perm_b32 v70, v60, v60, v50
    v_perm_b32 v71, v60, v60, v51
    v_perm_b32 v72, v66, v66, v48
    v_perm_b32 v73, v66, v66, v49
    v_perm_b32 v74, v66, v66, v50
    v_perm_b32 v75, v66, v66, v51
    s_waitcnt vmcnt(3)
    s_nop 0
    v_mfma_f32_16x16x32_bf16 v[84:87], v[68:71], v[224:227], v[84:87]
    v_mfma_f32_16x16x32_bf16 v[88:91], v[72:75], v[224:227], v[88:91]
    v_mfma_f32_16x16x32_bf16 v[92:95], v[68:71], v[228:231], v[92:95]
    v_mfma_f32_16x16x32_bf16 v[96:99], v[72:75], v[228:231], v[96:99]
    v_mfma_f32_16x16x32_bf16 v[100:103], v[68:71], v[232:235], v[100:103]
    v_mfma_f32_16x16x32_bf16 v[104:107], v[72:75], v[232:235], v[104:107]
    v_perm_b32 v76, v60, v60, v52
    v_perm_b32 v77, v60, v60, v53
    v_perm_b32 v78, v60, v60, v54
    v_perm_b32 v79, v60, v60, v55
    v_perm_b32 v80, v66, v66, v52
    v_perm_b32 v81, v66, v66, v53
    v_perm_b32 v82, v66, v66, v54
    v_perm_b32 v83, v66, v66, v55
    s_waitcnt vmcnt(0)
    s_nop 0
    v_mfma_f32_16x16x32_bf16 v[84:87], v[76:79], v[236:239], v[84:87]
    v_mfma_f32_16x16x32_bf16 v[88:91], v[80:83], v[236:239], v[88:91]
    v_mfma_f32_16x16x32_bf16 v[92:95], v[76:79], v[240:243], v[92:95]
    v_mfma_f32_16x16x32_bf16 v[96:99], v[80:83], v[240:243], v[96:99]
    v_mfma_f32_16x16x32_bf16 v[100:103], v[76:79], v[244:247], v[100:103]
    v_mfma_f32_16x16x32_bf16 v[104:107], v[80:83], v[244:247], v[104:107]
    v_mov_b32 v36, 3984
    s_mov_b32 s15, 1600000
L_lw_pf:
    ds_read_b32 v37, v36
    s_waitcnt lgkmcnt(0)
    v_cmp_eq_u32 vcc, 0, v37
    s_cbranch_vccz L_lw_pf_ok
    s_sleep 1
    s_sub_u32 s15, s15, 1
    s_cmp_lg_u32 s15, 0
    s_cbranch_scc1 L_lw_pf
L_lw_pf_ok:
    v_lshrrev_b32 v36, 5, v1
    v_mul_u32_u24 v36, 768, v36
    v_and_b32 v37, 7, v1
    v_lshl_add_u32 v36, v37, 5, v36
    v_bfe_u32 v37, v1, 4, 1
    v_lshl_add_u32 v36, v37, 4, v36
    v_and_b32 v37, 8, v1
    v_cmp_eq_u32 s[78:79], 0, v37
    v_permlane32_swap_b32 v84, v88
    v_permlane32_swap_b32 v85, v89
    v_permlane32_swap_b32 v86, v90
    v_permlane32_swap_b32 v87, v91
    s_nop 0
    v_add_f32_dpp v84, v88, v84 row_shl:8 row_mask:0xf bank_mask:0xf bound_ctrl:0
    v_add_f32_dpp v85, v89, v85 row_shl:8 row_mask:0xf bank_mask:0xf bound_ctrl:0
    v_add_f32_dpp v86, v90, v86 row_shl:8 row_mask:0xf bank_mask:0xf bound_ctrl:0
    v_add_f32_dpp v87, v91, v87 row_shl:8 row_mask:0xf bank_mask:0xf bound_ctrl:0
    v_permlane32_swap_b32 v92, v96
    v_permlane32_swap_b32 v93, v97
    v_permlane32_swap_b32 v94, v98
    v_permlane32_swap_b32 v95, v99
    s_nop 0
    v_add_f32_dpp v92, v96, v92 row_shl:8 row_mask:0xf bank_mask:0xf bound_ctrl:0
    v_add_f32_dpp v93, v97, v93 row_shl:8 row_mask:0xf bank_mask:0xf bound_ctrl:0
    v_add_f32_dpp v94, v98, v94 row_shl:8 row_mask:0xf bank_mask:0xf bound_ctrl:0
    v_add_f32_dpp v95, v99, v95 row_shl:8 row_mask:0xf bank_mask:0xf bound_ctrl:0
    v_permlane32_swap_b32 v100, v104
    v_permlane32_swap_b32 v101, v105
    v_permlane32_swap_b32 v102, v106
    v_permlane32_swap_b32 v103, v107
    s_nop 0
    v_add_f32_dpp v100, v104, v100 row_shl:8 row_mask:0xf bank_mask:0xf bound_ctrl:0
    v_add_f32_dpp v101, v105, v101 row_shl:8 row_mask:0xf bank_mask:0xf bound_ctrl:0
    v_add_f32_dpp v102, v106, v102 row_shl:8 row_mask:0xf bank_mask:0xf bound_ctrl:0
    v_add_f32_dpp v103, v107, v103 row_shl:8 row_mask:0xf bank_mask:0xf bound_ctrl:0
    v_min_u32 v84, -2, v84
    v_min_u32 v85, -2, v85
    v_min_u32 v86, -2, v86
    v_min_u32 v87, -2, v87
    v_min_u32 v92, -2, v92
    v_min_u32 v93, -2, v93
    v_min_u32 v94, -2, v94
    v_min_u32 v95, -2, v95
    v_min_u32 v100, -2, v100
    v_min_u32 v101, -2, v101
    v_min_u32 v102, -2, v102
    v_min_u32 v103, -2, v103
    s_mov_b64 exec, s[78:79]
    buffer_store_dwordx4 v[84:87], v36, s[48:51], s10 offen offset:0 sc1
    buffer_store_dwordx4 v[92:95], v36, s[48:51], s10 offen offset:256 sc1
    buffer_store_dwordx4 v[100:103], v36, s[48:51], s10 offen offset:512 sc1
    s_mov_b64 exec, -1
    v_mov_b32 v36, 3988
    s_mov_b32 s15, 1600000
L_lw_pa:
    ds_read_b32 v37, v36
    s_waitcnt lgkmcnt(0)
    v_cmp_eq_u32 vcc, 0, v37
    s_cbranch_vccz L_lw_pa_ok
    s_sleep 1
    s_sub_u32 s15, s15, 1
    s_cmp_lg_u32 s15, 0
    s_cbranch_scc1 L_lw_pa
L_lw_pa_ok:
    v_mul_u32_u24 v36, 24, v1
    v_add_u32 v38, 6144, v36
    s_mul_i32 s8, s4, 12288
    s_add_u32 s9, s8, 3072
    s_mov_b32 s11, 255
    s_mov_b32 s15, 200000
L_mg_q:
    s_bitcmp1_b32 s11, 0
    s_cbranch_scc0 L_mg_q_i0
    buffer_load_dwordx4 v[128:131], v36, s[48:51], s8 offen offset:0 sc1
    buffer_load_dwordx2 v[132:133], v36, s[48:51], s8 offen offset:16 sc1
L_mg_q_i0:
    s_bitcmp1_b32 s11, 1
    s_cbranch_scc0 L_mg_q_i1
    buffer_load_dwordx4 v[136:139], v36, s[48:51], s8 offen offset:1536 sc1
    buffer_load_dwordx2 v[140:141], v36, s[48:51], s8 offen offset:1552 sc1
L_mg_q_i1:
    s_bitcmp1_b32 s11, 2
    s_cbranch_scc0 L_mg_q_i2
    buffer_load_dwordx4 v[144:147], v36, s[48:51], s9 offen offset:0 sc1
    buffer_load_dwordx2 v[148:149], v36, s[48:51], s9 offen offset:16 sc1
L_mg_q_i2:
    s_bitcmp1_b32 s11, 3
    s_cbranch_scc0 L_mg_q_i3
    buffer_load_dwordx4 v[152:155], v36, s[48:51], s9 offen offset:1536 sc1
    buffer_load_dwordx2 v[156:157], v36, s[48:51], s9 offen offset:1552 sc1
L_mg_q_i3:
    s_bitcmp1_b32 s11, 4
    s_cbranch_scc0 L_mg_q_i4
    buffer_load_dwordx4 v[160:163], v38, s[48:51], s8 offen offset:0 sc1
    buffer_load_dwordx2 v[164:165], v38, s[48:51], s8 offen offset:16 sc1
L_mg_q_i4:
    s_bitcmp1_b32 s11, 5
    s_cbranch_scc0 L_mg_q_i5
    buffer_load_dwordx4 v[168:171], v38, s[48:51], s8 offen offset:1536 sc1
    buffer_load_dwordx2 v[172:173], v38, s[48:51], s8 offen offset:1552 sc1
L_mg_q_i5:
    s_bitcmp1_b32 s11, 6
    s_cbranch_scc0 L_mg_q_i6
    buffer_load_dwordx4 v[176:179], v38, s[48:51], s9 offen offset:0 sc1
    buffer_load_dwordx2 v[180:181], v38, s[48:51], s9 offen offset:16 sc1
L_mg_q_i6:
    s_bitcmp1_b32 s11, 7
    s_cbranch_scc0 L_mg_q_i7
    buffer_load_dwordx4 v[184:187], v38, s[48:51], s9 offen offset:1536 sc1
    buffer_load_dwordx2 v[188:189], v38, s[48:51], s9 offen offset:1552 sc1
L_mg_q_i7:
    s_waitcnt vmcnt(0)
    s_bitcmp1_b32 s11, 0
    s_cbranch_scc0 L_mg_q_c0
    v_max3_u32 v39, v128, v129, v130
    v_max3_u32 v39, v131, v132, v39
    v_max_u32 v39, v133, v39
    v_cmp_eq_u32 vcc, -1, v39
    s_cbranch_vccnz L_mg_q_c0
    s_bitset0_b32 s11, 0
L_mg_q_c0:
    s_bitcmp1_b32 s11, 1
    s_cbranch_scc0 L_mg_q_c1
    v_max3_u32 v39, v136, v137, v138
    v_max3_u32 v39, v139, v140, v39
    v_max_u32 v39, v141, v39
    v_cmp_eq_u32 vcc, -1, v39
    s_cbranch_vccnz L_mg_q_c1
    s_bitset0_b32 s11, 1
L_mg_q_c1:
    s_bitcmp1_b32 s11, 2
    s_cbranch_scc0 L_mg_q_c2
    v_max3_u32 v39, v144, v145, v146
    v_max3_u32 v39, v147, v148, v39
    v_max_u32 v39, v149, v39
    v_cmp_eq_u32 vcc, -1, v39
    s_cbranch_vccnz L_mg_q_c2
    s_bitset0_b32 s11, 2
L_mg_q_c2:
    s_bitcmp1_b32 s11, 3
    s_cbranch_scc0 L_mg_q_c3
    v_max3_u32 v39, v152, v153, v154
    v_max3_u32 v39, v155, v156, v39
    v_max_u32 v39, v157, v39
    v_cmp_eq_u32 vcc, -1, v39
    s_cbranch_vccnz L_mg_q_c3
    s_bitset0_b32 s11, 3
L_mg_q_c3:
    s_bitcmp1_b32 s11, 4
    s_cbranch_scc0 L_mg_q_c4
    v_max3_u32 v39, v160, v161, v162
    v_max3_u32 v39, v163, v164, v39
    v_max_u32 v39, v165, v39
    v_cmp_eq_u32 vcc, -1, v39
    s_cbranch_vccnz L_mg_q_c4
    s_bitset0_b32 s11, 4
L_mg_q_c4:
    s_bitcmp1_b32 s11, 5
    s_cbranch_scc0 L_mg_q_c5
    v_max3_u32 v39, v168, v169, v170
    v_max3_u32 v39, v171, v172, v39
    v_max_u32 v39, v173, v39
    v_cmp_eq_u32 vcc, -1, v39
    s_cbranch_vccnz L_mg_q_c5
    s_bitset0_b32 s11, 5
L_mg_q_c5:
    s_bitcmp1_b32 s11, 6
    s_cbranch_scc0 L_mg_q_c6
    v_max3_u32 v39, v176, v177, v178
    v_max3_u32 v39, v179, v180, v39
    v_max_u32 v39, v181, v39
    v_cmp_eq_u32 vcc, -1, v39
    s_cbranch_vccnz L_mg_q_c6
    s_bitset0_b32 s11, 6
L_mg_q_c6:
    s_bitcmp1_b32 s11, 7
    s_cbranch_scc0 L_mg_q_c7
    v_max3_u32 v39, v184, v185, v186
    v_max3_u32 v39, v187, v188, v39
    v_max_u32 v39, v189, v39
    v_cmp_eq_u32 vcc, -1, v39
    s_cbranch_vccnz L_mg_q_c7
    s_bitset0_b32 s11, 7
L_mg_q_c7:
    s_cmp_eq_u32 s11, 0
    s_cbranch_scc1 L_mg_q_ok
    s_sleep 2
    s_sub_u32 s15, s15, 1
    s_cmp_lg_u32 s15, 0
    s_cbranch_scc1 L_mg_q
L_mg_q_ok:
    v_mul_u32_u24 v37, 12, v1
    v_pk_add_f32 v[128:129], v[128:129], v[136:137]
    v_pk_add_f32 v[130:131], v[130:131], v[138:139]
    v_pk_add_f32 v[132:133], v[132:133], v[140:141]
    v_pk_add_f32 v[128:129], v[128:129], v[144:145]
    v_pk_add_f32 v[130:131], v[130:131], v[146:147]
    v_pk_add_f32 v[132:133], v[132:133], v[148:149]
    v_pk_add_f32 v[128:129], v[128:129], v[152:153]
    v_pk_add_f32 v[130:131], v[130:131], v[154:155]
    v_pk_add_f32 v[132:133], v[132:133], v[156:157]
    v_pk_add_f32 v[128:129], v[128:129], v[160:161]
    v_pk_add_f32 v[130:131], v[130:131], v[162:163]
    v_pk_add_f32 v[132:133], v[132:133], v[164:165]
    v_pk_add_f32 v[128:129], v[128:129], v[168:169]
    v_pk_add_f32 v[130:131], v[130:131], v[170:171]
    v_pk_add_f32 v[132:133], v[132:133], v[172:173]
    v_pk_add_f32 v[128:129], v[128:129], v[176:177]
    v_pk_add_f32 v[130:131], v[130:131], v[178:179]
    v_pk_add_f32 v[132:133], v[132:133], v[180:181]
    v_pk_add_f32 v[128:129], v[128:129], v[184:185]
    v_pk_add_f32 v[130:131], v[130:131], v[186:187]
    v_pk_add_f32 v[132:133], v[132:133], v[188:189]
    v_cvt_pk_bf16_f32 v40, v128, v129
    v_cvt_pk_bf16_f32 v41, v130, v131
    v_cvt_pk_bf16_f32 v42, v132, v133
    ds_write_b32 v37, v40 offset:2560
    ds_write_b32 v37, v41 offset:2564
    ds_write_b32 v37, v42 offset:2568
    v_mov_b32 v38, 3968
    v_mov_b32 v39, 1
    s_waitcnt lgkmcnt(0)
    ds_write_b32 v38, v39
    s_waitcnt lgkmcnt(0)
    s_cmp_eq_u32 s101, 1
    s_cbranch_scc0 L_adone
    s_setprio 0
    v_lshrrev_b32 v36, 5, v1
    v_mul_u32_u24 v36, 1280, v36
    v_and_b32 v37, 15, v1
    v_lshl_add_u32 v36, v37, 4, v36
    v_bfe_u32 v37, v1, 4, 1
    v_lshl_add_u32 v108, v37, 3, v36
    s_lshl_b32 s10, s4, 8
    buffer_load_dwordx2 v[2:3], v108, s[68:71], s10 offen
    s_mov_b32 s56, s34
    s_and_b32 s57, s35, 0xffff
    s_mov_b32 s58, 2560
    s_mov_b32 s59, 0x20000
    s_waitcnt vmcnt(0) lgkmcnt(0)
    v_lshlrev_b32 v20, 16, v2
    v_and_b32 v21, 0xffff0000, v2
    v_lshlrev_b32 v22, 16, v3
    v_and_b32 v23, 0xffff0000, v3
    s_mul_i32 s8, s4, 12288
    s_add_u32 s8, s8, 1245184
    s_add_u32 s9, s8, 4096
    s_add_u32 s11, s8, 8192
    s_barrier
    s_mov_b32 s15, 200000
    v_and_b32 v36, 31, v1
    v_lshlrev_b32 v36, 3, v36
L_pa_r:
    buffer_load_dword v37, v36, s[64:67], 0 offen sc1
    s_waitcnt vmcnt(0)
    v_cmp_gt_u32 vcc, 8, v37
    s_cbranch_vccz L_pa_r_ok
    s_sub_u32 s15, s15, 1
    s_cmp_lg_u32 s15, 0
    s_cbranch_scc1 L_pa_r
L_pa_r_ok:
    v_mov_b32 v38, 4000
    v_mov_b32 v39, 1
    ds_write_b32 v38, v39
    s_mov_b32 s15, 200000
L_polly:
    buffer_load_dwordx4 v[128:131], v110, s[48:51], s8 offen offset:0 sc1
    buffer_load_dwordx4 v[132:135], v110, s[48:51], s8 offen offset:1024 sc1
    buffer_load_dwordx4 v[136:139], v110, s[48:51], s8 offen offset:2048 sc1
    buffer_load_dwordx4 v[140:143], v110, s[48:51], s8 offen offset:3072 sc1
    buffer_load_dwordx4 v[144:147], v110, s[48:51], s9 offen offset:0 sc1
    buffer_load_dwordx4 v[148:151], v110, s[48:51], s9 offen offset:1024 sc1
    buffer_load_dwordx4 v[152:155], v110, s[48:51], s9 offen offset:2048 sc1
    buffer_load_dwordx4 v[156:159], v110, s[48:51], s9 offen offset:3072 sc1
    buffer_load_dwordx4 v[160:163], v110, s[48:51], s11 offen offset:0 sc1
    buffer_load_dwordx4 v[164:167], v110, s[48:51], s11 offen offset:1024 sc1
    buffer_load_dwordx4 v[168:171], v110, s[48:51], s11 offen offset:2048 sc1
    buffer_load_dwordx4 v[172:175], v110, s[48:51], s11 offen offset:3072 sc1
    s_waitcnt vmcnt(0)
    v_max3_u32 v39, v128, v129, v130
    v_max3_u32 v39, v131, v132, v39
    v_max3_u32 v39, v133, v134, v39
    v_max3_u32 v39, v135, v136, v39
    v_max3_u32 v39, v137, v138, v39
    v_max3_u32 v39, v139, v140, v39
    v_max3_u32 v39, v141, v142, v39
    v_max3_u32 v39, v143, v144, v39
    v_max3_u32 v39, v145, v146, v39
    v_max3_u32 v39, v147, v148, v39
    v_max3_u32 v39, v149, v150, v39
    v_max3_u32 v39, v151, v152, v39
    v_max3_u32 v39, v153, v154, v39
    v_max3_u32 v39, v155, v156, v39
    v_max3_u32 v39, v157, v158, v39
    v_max3_u32 v39, v159, v160, v39
    v_max3_u32 v39, v161, v162, v39
    v_max3_u32 v39, v163, v164, v39
    v_max3_u32 v39, v165, v166, v39
    v_max3_u32 v39, v167, v168, v39
    v_max3_u32 v39, v169, v170, v39
    v_max3_u32 v39, v171, v172, v39
    v_max3_u32 v39, v173, v174, v39
    v_max_u32 v39, v175, v39
    v_cmp_eq_u32 vcc, -1, v39
    s_cbranch_vccz L_polly_ok
    s_sleep 1
    s_sub_u32 s15, s15, 1
    s_cmp_lg_u32 s15, 0
    s_cbranch_scc1 L_polly
L_polly_ok:
    v_pk_add_f32 v[128:129], v[128:129], v[144:145]
    v_pk_add_f32 v[130:131], v[130:131], v[146:147]
    v_pk_add_f32 v[132:133], v[132:133], v[148:149]
    v_pk_add_f32 v[134:135], v[134:135], v[150:151]
    v_pk_add_f32 v[136:137], v[136:137], v[152:153]
    v_pk_add_f32 v[138:139], v[138:139], v[154:155]
    v_pk_add_f32 v[140:141], v[140:141], v[156:157]
    v_pk_add_f32 v[142:143], v[142:143], v[158:159]
    v_pk_add_f32 v[128:129], v[128:129], v[160:161]
    v_pk_add_f32 v[130:131], v[130:131], v[162:163]
    v_pk_add_f32 v[132:133], v[132:133], v[164:165]
    v_pk_add_f32 v[134:135], v[134:135], v[166:167]
    v_pk_add_f32 v[136:137], v[136:137], v[168:169]
    v_pk_add_f32 v[138:139], v[138:139], v[170:171]
    v_pk_add_f32 v[140:141], v[140:141], v[172:173]
    v_pk_add_f32 v[142:143], v[142:143], v[174:175]
    v_pk_add_f32 v[128:129], v[128:129], v[136:137]
    v_pk_add_f32 v[130:131], v[130:131], v[138:139]
    v_pk_add_f32 v[132:133], v[132:133], v[140:141]
    v_pk_add_f32 v[134:135], v[134:135], v[142:143]
    v_pk_add_f32 v[128:129], v[128:129], v[132:133]
    v_pk_add_f32 v[130:131], v[130:131], v[134:135]
    v_cvt_pk_bf16_f32 v128, 0, v128
    v_cvt_pk_bf16_f32 v129, 0, v129
    v_cvt_pk_bf16_f32 v130, 0, v130
    v_cvt_pk_bf16_f32 v131, 0, v131
    v_mul_f32 v16, 0xbfb8aa3b, v128
    v_mul_f32 v17, 0xbfb8aa3b, v129
    v_mul_f32 v18, 0xbfb8aa3b, v130
    v_mul_f32 v19, 0xbfb8aa3b, v131
    v_exp_f32 v16, v16
    v_exp_f32 v17, v17
    v_exp_f32 v18, v18
    v_exp_f32 v19, v19
    s_nop 0
    v_add_f32 v16, 1.0, v16
    v_add_f32 v17, 1.0, v17
    v_add_f32 v18, 1.0, v18
    v_add_f32 v19, 1.0, v19
    v_rcp_f32 v16, v16
    v_rcp_f32 v17, v17
    v_rcp_f32 v18, v18
    v_rcp_f32 v19, v19
    s_nop 0
    v_mul_f32 v16, v16, v128
    v_mul_f32 v17, v17, v129
    v_mul_f32 v18, v18, v130
    v_mul_f32 v19, v19, v131
    v_cvt_pk_bf16_f32 v16, 0, v16
    v_cvt_pk_bf16_f32 v17, 0, v17
    v_cvt_pk_bf16_f32 v18, 0, v18
    v_cvt_pk_bf16_f32 v19, 0, v19
    s_barrier
    ds_read_b128 v[128:131], v110 offset:16384
    ds_read_b128 v[132:135], v110 offset:17408
    ds_read_b128 v[136:139], v110 offset:18432
    ds_read_b128 v[140:143], v110 offset:19456
    s_waitcnt lgkmcnt(2)
    v_pk_add_f32 v[128:129], v[128:129], v[132:133]
    v_pk_add_f32 v[130:131], v[130:131], v[134:135]
    s_waitcnt lgkmcnt(0)
    v_pk_add_f32 v[136:137], v[136:137], v[140:141]
    v_pk_add_f32 v[138:139], v[138:139], v[142:143]
    v_pk_add_f32 v[128:129], v[128:129], v[136:137]
    v_pk_add_f32 v[130:131], v[130:131], v[138:139]
    v_cvt_pk_bf16_f32 v128, 0, v128
    v_cvt_pk_bf16_f32 v129, 0, v129
    v_cvt_pk_bf16_f32 v130, 0, v130
    v_cvt_pk_bf16_f32 v131, 0, v131
    v_pk_mul_f32 v[128:129], v[128:129], v[16:17]
    v_pk_mul_f32 v[130:131], v[130:131], v[18:19]
    v_cvt_pk_bf16_f32 v128, 0, v128
    v_cvt_pk_bf16_f32 v129, 0, v129
    v_cvt_pk_bf16_f32 v130, 0, v130
    v_cvt_pk_bf16_f32 v131, 0, v131
    v_pk_add_f32 v[128:129], v[128:129], v[20:21]
    v_pk_add_f32 v[130:131], v[130:131], v[22:23]
    v_cvt_pk_bf16_f32 v136, v128, v129
    v_cvt_pk_bf16_f32 v137, v130, v131
    buffer_store_dwordx2 v[136:137], v108, s[56:59], s10 offen
    s_branch L_adone
.p2align 3
L_ffnw:
    s_mul_i32 s100, s4, 3
    s_add_u32 s100, s100, s6
    s_sub_u32 s100, s100, 5
    s_cmp_eq_u32 s3, 7
    s_cbranch_scc1 L_w7
    s_cmp_lt_u32 s6, 5
    s_cbranch_scc1 L_end
    v_lshrrev_b32 v36, 4, v1
    v_mul_u32_u24 v109, 61440, v36
    v_and_b32 v37, 15, v1
    v_lshl_add_u32 v109, v37, 4, v109
    v_mul_u32_u24 v108, 40, v36
    v_bfe_u32 v37, v1, 3, 1
    v_mul_u32_u24 v37, 1280, v37
    v_add_u32 v108, v108, v37
    s_and_b32 s8, s100, 7
    s_mul_i32 s9, s8, 160
    v_add_u32 v108, s9, v108
    s_mul_i32 s12, s8, 245760
    s_lshr_b32 s8, s100, 3
    s_lshl_b32 s8, s8, 8
    s_add_u32 s12, s12, s8
    s_waitcnt lgkmcnt(0)
    s_cmp_eq_u32 s3, 5
    s_cselect_b32 s52, s28, s30
    s_cselect_b32 s53, s29, s31
    s_and_b32 s53, s53, 0xffff
    s_mov_b32 s54, 1966080
    s_mov_b32 s55, 0x20000
    s_mov_b32 s48, s38
    s_and_b32 s49, s39, 0xffff
    s_mov_b32 s50, 2097152
    s_mov_b32 s51, 0x20000
    v_and_b32 v36, 1, v1
    v_cmp_eq_u32 vcc, 1, v36
    v_mov_b32 v36, 0x0c0c0100
    v_mov_b32 v37, 0x01000c0c
    v_cndmask_b32 v36, v36, v37, vcc
    v_mov_b32 v37, 0x0c0c0302
    v_mov_b32 v38, 0x03020c0c
    v_cndmask_b32 v37, v37, v38, vcc
    v_mov_b32 v38, 0x0c0c0c0c
    v_bfe_u32 v39, v1, 1, 2
    v_cmp_eq_u32 vcc, 0, v39
    s_nop 1
    v_cndmask_b32 v48, v38, v36, vcc
    v_cndmask_b32 v52, v38, v37, vcc
    v_cmp_eq_u32 vcc, 1, v39
    s_nop 1
    v_cndmask_b32 v49, v38, v36, vcc
    v_cndmask_b32 v53, v38, v37, vcc
    v_cmp_eq_u32 vcc, 2, v39
    s_nop 1
    v_cndmask_b32 v50, v38, v36, vcc
    v_cndmask_b32 v54, v38, v37, vcc
    v_cmp_eq_u32 vcc, 3, v39
    s_nop 1
    v_cndmask_b32 v51, v38, v36, vcc
    v_cndmask_b32 v55, v38, v37, vcc
    v_lshlrev_b32 v110, 4, v1
    s_lshl_b32 s10, s100, 11
    s_sub_u32 s8, s3, 5
    s_lshl_b32 s8, s8, 10
    s_add_u32 s10, s10, s8
    s_add_u32 s10, s10, 1310720
    s_barrier
    v_mov_b32 v36, 3968
    s_mov_b32 s15, 1600000
L_lw_gu:
    ds_read_b32 v37, v36
    s_waitcnt lgkmcnt(0)
    v_cmp_eq_u32 vcc, 0, v37
    s_cbranch_vccz L_lw_gu_ok
    s_sleep 8
    s_sub_u32 s15, s15, 1
    s_cmp_lg_u32 s15, 0
    s_cbranch_scc1 L_lw_gu
L_lw_gu_ok:
    s_setprio 2
    ds_read_b64 v[2:3], v108 offset:0
    ds_read_b64 v[4:5], v108 offset:8
    ds_read_b64 v[6:7], v108 offset:16
    ds_read_b64 v[8:9], v108 offset:24
    ds_read_b64 v[10:11], v108 offset:32
    buffer_load_dwordx4 v[128:131], v109, s[52:55], s12 offen nt
    s_add_u32 s12, s12, 3072
    buffer_load_dwordx4 v[132:135], v109, s[52:55], s12 offen nt
    s_add_u32 s12, s12, 3072
    buffer_load_dwordx4 v[136:139], v109, s[52:55], s12 offen nt
    s_add_u32 s12, s12, 3072
    buffer_load_dwordx4 v[140:143], v109, s[52:55], s12 offen nt
    s_add_u32 s12, s12, 3072
    buffer_load_dwordx4 v[144:147], v109, s[52:55], s12 offen nt
    s_add_u32 s12, s12, 3072
    s_waitcnt lgkmcnt(0)
    v_perm_b32 v68, v2, v2, v48
    v_perm_b32 v69, v2, v2, v49
    v_perm_b32 v70, v2, v2, v50
    v_perm_b32 v71, v2, v2, v51
    s_waitcnt vmcnt(4)
    buffer_load_dwordx4 v[148:151], v109, s[52:55], s12 offen nt
    s_add_u32 s12, s12, 3072
    v_mfma_f32_16x16x32_bf16 v[84:87], v[68:71], v[128:131], 0
    v_perm_b32 v72, v2, v2, v52
    v_perm_b32 v73, v2, v2, v53
    v_perm_b32 v74, v2, v2, v54
    v_perm_b32 v75, v2, v2, v55
    s_waitcnt vmcnt(4)
    buffer_load_dwordx4 v[152:155], v109, s[52:55], s12 offen nt
    s_add_u32 s12, s12, 3072
    v_mfma_f32_16x16x32_bf16 v[84:87], v[72:75], v[132:135], v[84:87]
    v_perm_b32 v68, v3, v3, v48
    v_perm_b32 v69, v3, v3, v49
    v_perm_b32 v70, v3, v3, v50
    v_perm_b32 v71, v3, v3, v51
    s_waitcnt vmcnt(4)
    buffer_load_dwordx4 v[156:159], v109, s[52:55], s12 offen nt
    s_add_u32 s12, s12, 3072
    v_mfma_f32_16x16x32_bf16 v[84:87], v[68:71], v[136:139], v[84:87]
    v_perm_b32 v72, v3, v3, v52
    v_perm_b32 v73, v3, v3, v53
    v_perm_b32 v74, v3, v3, v54
    v_perm_b32 v75, v3, v3, v55
    s_waitcnt vmcnt(4)
    buffer_load_dwordx4 v[160:163], v109, s[52:55], s12 offen nt
    s_add_u32 s12, s12, 3072
    v_mfma_f32_16x16x32_bf16 v[84:87], v[72:75], v[140:143], v[84:87]
    v_perm_b32 v68, v4, v4, v48
    v_perm_b32 v69, v4, v4, v49
    v_perm_b32 v70, v4, v4, v50
    v_perm_b32 v71, v4, v4, v51
    s_waitcnt vmcnt(4)
    buffer_load_dwordx4 v[164:167], v109, s[52:55], s12 offen nt
    s_add_u32 s12, s12, 3072
    v_mfma_f32_16x16x32_bf16 v[84:87], v[68:71], v[144:147], v[84:87]
    v_perm_b32 v72, v4, v4, v52
    v_perm_b32 v73, v4, v4, v53
    v_perm_b32 v74, v4, v4, v54
    v_perm_b32 v75, v4, v4, v55
    s_waitcnt vmcnt(4)
    buffer_load_dwordx4 v[168:171], v109, s[52:55], s12 offen nt
    s_add_u32 s12, s12, 3072
    v_mfma_f32_16x16x32_bf16 v[84:87], v[72:75], v[148:151], v[84:87]
    v_perm_b32 v68, v5, v5, v48
    v_perm_b32 v69, v5, v5, v49
    v_perm_b32 v70, v5, v5, v50
    v_perm_b32 v71, v5, v5, v51
    s_waitcnt vmcnt(4)
    buffer_load_dwordx4 v[172:175], v109, s[52:55], s12 offen nt
    s_add_u32 s12, s12, 3072
    v_mfma_f32_16x16x32_bf16 v[84:87], v[68:71], v[152:155], v[84:87]
    v_perm_b32 v72, v5, v5, v52
    v_perm_b32 v73, v5, v5, v53
    v_perm_b32 v74, v5, v5, v54
    v_perm_b32 v75, v5, v5, v55
    s_waitcnt vmcnt(4)
    buffer_load_dwordx4 v[176:179], v109, s[52:55], s12 offen nt
    s_add_u32 s12, s12, 3072
    v_mfma_f32_16x16x32_bf16 v[84:87], v[72:75], v[156:159], v[84:87]
    v_perm_b32 v68, v6, v6, v48
    v_perm_b32 v69, v6, v6, v49
    v_perm_b32 v70, v6, v6, v50
    v_perm_b32 v71, v6, v6, v51
    s_waitcnt vmcnt(4)
    buffer_load_dwordx4 v[180:183], v109, s[52:55], s12 offen nt
    s_add_u32 s12, s12, 3072
    v_mfma_f32_16x16x32_bf16 v[84:87], v[68:71], v[160:163], v[84:87]
    v_perm_b32 v72, v6, v6, v52
    v_perm_b32 v73, v6, v6, v53
    v_perm_b32 v74, v6, v6, v54
    v_perm_b32 v75, v6, v6, v55
    s_waitcnt vmcnt(4)
    buffer_load_dwordx4 v[184:187], v109, s[52:55], s12 offen nt
    s_add_u32 s12, s12, 3072
    v_mfma_f32_16x16x32_bf16 v[84:87], v[72:75], v[164:167], v[84:87]
    v_perm_b32 v68, v7, v7, v48
    v_perm_b32 v69, v7, v7, v49
    v_perm_b32 v70, v7, v7, v50
    v_perm_b32 v71, v7, v7, v51
    s_waitcnt vmcnt(4)
    buffer_load_dwordx4 v[188:191], v109, s[52:55], s12 offen nt
    s_add_u32 s12, s12, 3072
    v_mfma_f32_16x16x32_bf16 v[84:87], v[68:71], v[168:171], v[84:87]
    v_perm_b32 v72, v7, v7, v52
    v_perm_b32 v73, v7, v7, v53
    v_perm_b32 v74, v7, v7, v54
    v_perm_b32 v75, v7, v7, v55
    s_waitcnt vmcnt(4)
    buffer_load_dwordx4 v[192:195], v109, s[52:55], s12 offen nt
    s_add_u32 s12, s12, 3072
    v_mfma_f32_16x16x32_bf16 v[84:87], v[72:75], v[172:175], v[84:87]
    v_perm_b32 v68, v8, v8, v48
    v_perm_b32 v69, v8, v8, v49
    v_perm_b32 v70, v8, v8, v50
    v_perm_b32 v71, v8, v8, v51
    s_waitcnt vmcnt(4)
    buffer_load_dwordx4 v[196:199], v109, s[52:55], s12 offen nt
    s_add_u32 s12, s12, 3072
    v_mfma_f32_16x16x32_bf16 v[84:87], v[68:71], v[176:179], v[84:87]
    v_perm_b32 v72, v8, v8, v52
    v_perm_b32 v73, v8, v8, v53
    v_perm_b32 v74, v8, v8, v54
    v_perm_b32 v75, v8, v8, v55
    s_waitcnt vmcnt(4)
    buffer_load_dwordx4 v[200:203], v109, s[52:55], s12 offen nt
    s_add_u32 s12, s12, 3072
    v_mfma_f32_16x16x32_bf16 v[84:87], v[72:75], v[180:183], v[84:87]
    v_perm_b32 v68, v9, v9, v48
    v_perm_b32 v69, v9, v9, v49
    v_perm_b32 v70, v9, v9, v50
    v_perm_b32 v71, v9, v9, v51
    s_waitcnt vmcnt(4)
    buffer_load_dwordx4 v[204:207], v109, s[52:55], s12 offen nt
    s_add_u32 s12, s12, 3072
    v_mfma_f32_16x16x32_bf16 v[84:87], v[68:71], v[184:187], v[84:87]
    v_perm_b32 v72, v9, v9, v52
    v_perm_b32 v73, v9, v9, v53
    v_perm_b32 v74, v9, v9, v54
    v_perm_b32 v75, v9, v9, v55
    s_waitcnt vmcnt(4)
    s_nop 0
    v_mfma_f32_16x16x32_bf16 v[84:87], v[72:75], v[188:191], v[84:87]
    v_perm_b32 v68, v10, v10, v48
    v_perm_b32 v69, v10, v10, v49
    v_perm_b32 v70, v10, v10, v50
    v_perm_b32 v71, v10, v10, v51
    s_waitcnt vmcnt(3)
    s_nop 0
    v_mfma_f32_16x16x32_bf16 v[84:87], v[68:71], v[192:195], v[84:87]
    v_perm_b32 v72, v10, v10, v52
    v_perm_b32 v73, v10, v10, v53
    v_perm_b32 v74, v10, v10, v54
    v_perm_b32 v75, v10, v10, v55
    s_waitcnt vmcnt(2)
    s_nop 0
    v_mfma_f32_16x16x32_bf16 v[84:87], v[72:75], v[196:199], v[84:87]
    v_perm_b32 v68, v11, v11, v48
    v_perm_b32 v69, v11, v11, v49
    v_perm_b32 v70, v11, v11, v50
    v_perm_b32 v71, v11, v11, v51
    s_waitcnt vmcnt(1)
    s_nop 0
    v_mfma_f32_16x16x32_bf16 v[84:87], v[68:71], v[200:203], v[84:87]
    v_perm_b32 v72, v11, v11, v52
    v_perm_b32 v73, v11, v11, v53
    v_perm_b32 v74, v11, v11, v54
    v_perm_b32 v75, v11, v11, v55
    s_waitcnt vmcnt(0)
    s_nop 0
    v_mfma_f32_16x16x32_bf16 v[84:87], v[72:75], v[204:207], v[84:87]
    s_nop 7
    v_min_u32 v84, -2, v84
    v_min_u32 v85, -2, v85
    v_min_u32 v86, -2, v86
    v_min_u32 v87, -2, v87
    buffer_store_dwordx4 v[84:87], v110, s[48:51], s10 offen sc1
    s_lshl_b32 s8, s3, 2
    s_add_u32 s8, s8, 3956
    v_mov_b32 v37, s8
    v_mov_b32 v38, 1
    ds_write_b32 v37, v38
    s_waitcnt lgkmcnt(0)
    s_branch L_adone
L_w7:
    s_lshl_b32 s56, s4, 1
    s_add_u32 s56, s56, s6
    s_sub_u32 s56, s56, 5
    s_sub_u32 s8, s6, 5
    s_cmp_lt_u32 s8, 2
    s_cselect_b32 s56, s56, 255
    s_mul_i32 s57, s56, 52
    s_lshr_b32 s57, s57, 8
    s_mul_i32 s8, s57, 5
    s_sub_u32 s74, s56, s8
    s_mul_i32 s75, s74, 12288
    s_lshl_b32 s8, s57, 10
    s_add_u32 s75, s75, s8
    s_add_u32 s75, s75, 1245184
    s_setprio 3
    v_mov_b32 v12, -1
    v_mov_b32 v13, -1
    v_mov_b32 v14, -1
    v_mov_b32 v15, -1
    v_lshlrev_b32 v33, 4, v1
    v_lshlrev_b32 v36, 3, v1
    v_mov_b32 v37, 0
    v_mov_b32 v38, 1
    s_mul_i32 s10, s2, 1536
    s_lshl_b32 s8, s2, 11
    s_add_u32 s8, s8, 524288
    s_waitcnt lgkmcnt(0)
    s_mov_b32 s48, s38
    s_and_b32 s49, s39, 0xffff
    s_mov_b32 s50, 2097152
    s_mov_b32 s51, 0x20000
    buffer_store_dwordx4 v[12:15], v33, s[48:51], s10 offen sc1
    buffer_store_dwordx2 v[12:13], v36, s[48:51], s10 offen offset:1024 sc1
    buffer_store_dwordx4 v[12:15], v33, s[48:51], s8 offen sc1
    buffer_store_dwordx4 v[12:15], v33, s[48:51], s8 offen offset:1024 sc1
    s_cmp_lt_u32 s6, 5
    s_cbranch_scc0 L_pf_b
    s_lshl_b32 s8, s6, 15
    s_lshl_b32 s9, s4, 10
    s_add_u32 s8, s8, s9
    s_add_u32 s8, s8, 1048576
    buffer_store_dwordx4 v[12:15], v33, s[48:51], s8 offen sc1
    s_branch L_pf_c
L_pf_b:
    s_lshl_b32 s9, s100, 11
    s_add_u32 s8, s9, 1310720
    buffer_store_dwordx4 v[12:15], v33, s[48:51], s8 offen sc1
    buffer_store_dwordx4 v[12:15], v33, s[48:51], s8 offen offset:1024 sc1
    s_cmp_lt_u32 s56, 60
    s_cbranch_scc0 L_pf_c
    buffer_store_dwordx4 v[12:15], v33, s[48:51], s75 offen sc1
L_pf_c:
    s_cmp_eq_u32 s5, 0
    s_cbranch_scc0 L_pf_d
    s_mul_i32 s8, s4, 4096
    s_add_u32 s8, s8, 1835008
    s_mov_b64 exec, 1
    buffer_store_dword v37, off, s[48:51], s8 sc1
    s_mov_b64 exec, -1
L_pf_d:
    s_mov_b32 s64, s36
    s_and_b32 s65, s37, 0xffff
    s_mov_b32 s66, 256
    s_mov_b32 s67, 0x20000
    s_lshl_b32 s76, s4, 3
    s_barrier
    s_waitcnt vmcnt(0)
    s_mov_b64 exec, 1
    buffer_atomic_add v38, off, s[64:67], s76 sc0 sc1
    v_mov_b32 v40, 3984
    v_mov_b32 v41, 1
    s_waitcnt lgkmcnt(0)
    ds_write_b32 v40, v41
    s_mov_b32 s15, 200000
    s_waitcnt vmcnt(0)
    v_add_u32 v38, 1, v38
    s_branch L_pollq_chk
L_pollq:
    buffer_load_dword v38, off, s[64:67], s76 sc1
    s_waitcnt vmcnt(0)
L_pollq_chk:
    v_cmp_gt_u32 vcc, 8, v38
    s_cbranch_vccz L_pollq_ok
    s_sleep 2
    s_sub_u32 s15, s15, 1
    s_cmp_lg_u32 s15, 0
    s_cbranch_scc1 L_pollq
L_pollq_ok:
    v_mov_b32 v40, 3988
    v_mov_b32 v41, 1
    s_waitcnt lgkmcnt(0)
    ds_write_b32 v40, v41
    s_mov_b64 exec, -1
    s_waitcnt lgkmcnt(0)
    s_cmp_lt_u32 s56, 60
    s_cbranch_scc0 L_adone
    s_setprio 0
    s_mov_b32 s60, s32
    s_and_b32 s61, s33, 0xffff
    s_mov_b32 s62, 1966080
    s_mov_b32 s63, 0x20000
    v_and_b32 v36, 1, v1
    v_cmp_eq_u32 vcc, 1, v36
    v_mov_b32 v36, 0x0c0c0100
    v_mov_b32 v37, 0x01000c0c
    v_cndmask_b32 v36, v36, v37, vcc
    v_mov_b32 v37, 0x0c0c0302
    v_mov_b32 v38, 0x03020c0c
    v_cndmask_b32 v37, v37, v38, vcc
    v_mov_b32 v38, 0x0c0c0c0c
    v_bfe_u32 v39, v1, 1, 2
    v_cmp_eq_u32 vcc, 0, v39
    s_nop 1
    v_cndmask_b32 v48, v38, v36, vcc
    v_cndmask_b32 v52, v38, v37, vcc
    v_cmp_eq_u32 vcc, 1, v39
    s_nop 1
    v_cndmask_b32 v49, v38, v36, vcc
    v_cndmask_b32 v53, v38, v37, vcc
    v_cmp_eq_u32 vcc, 2, v39
    s_nop 1
    v_cndmask_b32 v50, v38, v36, vcc
    v_cndmask_b32 v54, v38, v37, vcc
    v_cmp_eq_u32 vcc, 3, v39
    s_nop 1
    v_cndmask_b32 v51, v38, v36, vcc
    v_cndmask_b32 v55, v38, v37, vcc
    v_lshrrev_b32 v42, 4, v1
    v_mul_u32_u24 v32, 40960, v42
    v_and_b32 v41, 15, v1
    v_lshl_add_u32 v32, v41, 4, v32
    s_mul_i32 s12, s57, 163840
    s_lshl_b32 s8, s74, 8
    s_add_u32 s12, s12, s8
    v_lshrrev_b32 v43, 5, v1
    v_lshlrev_b32 v43, 8, v43
    v_lshl_add_u32 v43, v41, 4, v43
    v_bfe_u32 v41, v1, 4, 1
    v_lshl_add_u32 v43, v41, 3, v43
    v_bfe_u32 v44, v1, 3, 1
    v_lshlrev_b32 v44, 8, v44
    v_lshl_add_u32 v44, v42, 6, v44
    v_add_u32 v45, 4096, v33
    v_add_u32 v46, 8192, v33
    v_add_u32 v47, 12288, v33
    s_lshl_b32 s10, s57, 14
    s_add_u32 s10, s10, 1310720
    s_mul_i32 s8, s57, 683
    s_lshr_b32 s8, s8, 8
    s_mov_b32 s15, 200000
    v_and_b32 v36, 3, v1
    v_add_u32 v36, s8, v36
    v_min_u32 v36, 31, v36
    v_lshlrev_b32 v36, 3, v36
L_pa_d:
    buffer_load_dword v37, v36, s[64:67], 0 offen sc1
    s_waitcnt vmcnt(0)
    v_cmp_gt_u32 vcc, 8, v37
    s_cbranch_vccz L_pa_d_ok
    s_sleep 8
    s_sub_u32 s15, s15, 1
    s_cmp_lg_u32 s15, 0
    s_cbranch_scc1 L_pa_d
L_pa_d_ok:
    v_mov_b32 v36, 3976
    s_mov_b32 s15, 1600000
L_lw_gu7:
    ds_read_b32 v37, v36
    s_waitcnt lgkmcnt(0)
    v_cmp_eq_u32 vcc, 0, v37
    s_cbranch_vccz L_lw_gu7_ok
    s_sleep 16
    s_sub_u32 s15, s15, 1
    s_cmp_lg_u32 s15, 0
    s_cbranch_scc1 L_lw_gu7
L_lw_gu7_ok:
    v_mov_b32 v36, 3980
    s_mov_b32 s15, 1600000
L_lw_gu8:
    ds_read_b32 v37, v36
    s_waitcnt lgkmcnt(0)
    v_cmp_eq_u32 vcc, 0, v37
    s_cbranch_vccz L_lw_gu8_ok
    s_sleep 16
    s_sub_u32 s15, s15, 1
    s_cmp_lg_u32 s15, 0
    s_cbranch_scc1 L_lw_gu8
L_lw_gu8_ok:
    s_mov_b32 s11, 255
    s_mov_b32 s15, 200000
L_mg_g:
    s_bitcmp1_b32 s11, 0
    s_cbranch_scc0 L_mg_g_i0
    buffer_load_dwordx4 v[64:67], v33, s[48:51], s10 offen offset:0 sc1
    buffer_load_dwordx4 v[68:71], v33, s[48:51], s10 offen offset:1024 sc1
L_mg_g_i0:
    s_bitcmp1_b32 s11, 1
    s_cbranch_scc0 L_mg_g_i1
    buffer_load_dwordx4 v[72:75], v33, s[48:51], s10 offen offset:2048 sc1
    buffer_load_dwordx4 v[76:79], v33, s[48:51], s10 offen offset:3072 sc1
L_mg_g_i1:
    s_bitcmp1_b32 s11, 2
    s_cbranch_scc0 L_mg_g_i2
    buffer_load_dwordx4 v[80:83], v45, s[48:51], s10 offen offset:0 sc1
    buffer_load_dwordx4 v[84:87], v45, s[48:51], s10 offen offset:1024 sc1
L_mg_g_i2:
    s_bitcmp1_b32 s11, 3
    s_cbranch_scc0 L_mg_g_i3
    buffer_load_dwordx4 v[88:91], v45, s[48:51], s10 offen offset:2048 sc1
    buffer_load_dwordx4 v[92:95], v45, s[48:51], s10 offen offset:3072 sc1
L_mg_g_i3:
    s_bitcmp1_b32 s11, 4
    s_cbranch_scc0 L_mg_g_i4
    buffer_load_dwordx4 v[96:99], v46, s[48:51], s10 offen offset:0 sc1
    buffer_load_dwordx4 v[100:103], v46, s[48:51], s10 offen offset:1024 sc1
L_mg_g_i4:
    s_bitcmp1_b32 s11, 5
    s_cbranch_scc0 L_mg_g_i5
    buffer_load_dwordx4 v[104:107], v46, s[48:51], s10 offen offset:2048 sc1
    buffer_load_dwordx4 v[108:111], v46, s[48:51], s10 offen offset:3072 sc1
L_mg_g_i5:
    s_bitcmp1_b32 s11, 6
    s_cbranch_scc0 L_mg_g_i6
    buffer_load_dwordx4 v[112:115], v47, s[48:51], s10 offen offset:0 sc1
    buffer_load_dwordx4 v[116:119], v47, s[48:51], s10 offen offset:1024 sc1
L_mg_g_i6:
    s_bitcmp1_b32 s11, 7
    s_cbranch_scc0 L_mg_g_i7
    buffer_load_dwordx4 v[120:123], v47, s[48:51], s10 offen offset:2048 sc1
    buffer_load_dwordx4 v[124:127], v47, s[48:51], s10 offen offset:3072 sc1
L_mg_g_i7:
    s_waitcnt vmcnt(0)
    s_bitcmp1_b32 s11, 0
    s_cbranch_scc0 L_mg_g_c0
    v_max3_u32 v39, v64, v65, v66
    v_max3_u32 v39, v67, v68, v39
    v_max3_u32 v39, v69, v70, v39
    v_max_u32 v39, v71, v39
    v_cmp_eq_u32 vcc, -1, v39
    s_cbranch_vccnz L_mg_g_c0
    s_bitset0_b32 s11, 0
L_mg_g_c0:
    s_bitcmp1_b32 s11, 1
    s_cbranch_scc0 L_mg_g_c1
    v_max3_u32 v39, v72, v73, v74
    v_max3_u32 v39, v75, v76, v39
    v_max3_u32 v39, v77, v78, v39
    v_max_u32 v39, v79, v39
    v_cmp_eq_u32 vcc, -1, v39
    s_cbranch_vccnz L_mg_g_c1
    s_bitset0_b32 s11, 1
L_mg_g_c1:
    s_bitcmp1_b32 s11, 2
    s_cbranch_scc0 L_mg_g_c2
    v_max3_u32 v39, v80, v81, v82
    v_max3_u32 v39, v83, v84, v39
    v_max3_u32 v39, v85, v86, v39
    v_max_u32 v39, v87, v39
    v_cmp_eq_u32 vcc, -1, v39
    s_cbranch_vccnz L_mg_g_c2
    s_bitset0_b32 s11, 2
L_mg_g_c2:
    s_bitcmp1_b32 s11, 3
    s_cbranch_scc0 L_mg_g_c3
    v_max3_u32 v39, v88, v89, v90
    v_max3_u32 v39, v91, v92, v39
    v_max3_u32 v39, v93, v94, v39
    v_max_u32 v39, v95, v39
    v_cmp_eq_u32 vcc, -1, v39
    s_cbranch_vccnz L_mg_g_c3
    s_bitset0_b32 s11, 3
L_mg_g_c3:
    s_bitcmp1_b32 s11, 4
    s_cbranch_scc0 L_mg_g_c4
    v_max3_u32 v39, v96, v97, v98
    v_max3_u32 v39, v99, v100, v39
    v_max3_u32 v39, v101, v102, v39
    v_max_u32 v39, v103, v39
    v_cmp_eq_u32 vcc, -1, v39
    s_cbranch_vccnz L_mg_g_c4
    s_bitset0_b32 s11, 4
L_mg_g_c4:
    s_bitcmp1_b32 s11, 5
    s_cbranch_scc0 L_mg_g_c5
    v_max3_u32 v39, v104, v105, v106
    v_max3_u32 v39, v107, v108, v39
    v_max3_u32 v39, v109, v110, v39
    v_max_u32 v39, v111, v39
    v_cmp_eq_u32 vcc, -1, v39
    s_cbranch_vccnz L_mg_g_c5
    s_bitset0_b32 s11, 5
L_mg_g_c5:
    s_bitcmp1_b32 s11, 6
    s_cbranch_scc0 L_mg_g_c6
    v_max3_u32 v39, v112, v113, v114
    v_max3_u32 v39, v115, v116, v39
    v_max3_u32 v39, v117, v118, v39
    v_max_u32 v39, v119, v39
    v_cmp_eq_u32 vcc, -1, v39
    s_cbranch_vccnz L_mg_g_c6
    s_bitset0_b32 s11, 6
L_mg_g_c6:
    s_bitcmp1_b32 s11, 7
    s_cbranch_scc0 L_mg_g_c7
    v_max3_u32 v39, v120, v121, v122
    v_max3_u32 v39, v123, v124, v39
    v_max3_u32 v39, v125, v126, v39
    v_max_u32 v39, v127, v39
    v_cmp_eq_u32 vcc, -1, v39
    s_cbranch_vccnz L_mg_g_c7
    s_bitset0_b32 s11, 7
L_mg_g_c7:
    s_cmp_eq_u32 s11, 0
    s_cbranch_scc1 L_mg_g_ok
    s_sleep 32
    s_sub_u32 s15, s15, 1
    s_cmp_lg_u32 s15, 0
    s_cbranch_scc1 L_mg_g
L_mg_g_ok:
    v_pk_add_f32 v[64:65], v[64:65], v[96:97]
    v_pk_add_f32 v[66:67], v[66:67], v[98:99]
    v_pk_add_f32 v[68:69], v[68:69], v[100:101]
    v_pk_add_f32 v[70:71], v[70:71], v[102:103]
    v_pk_add_f32 v[72:73], v[72:73], v[104:105]
    v_pk_add_f32 v[74:75], v[74:75], v[106:107]
    v_pk_add_f32 v[76:77], v[76:77], v[108:109]
    v_pk_add_f32 v[78:79], v[78:79], v[110:111]
    v_pk_add_f32 v[80:81], v[80:81], v[112:113]
    v_pk_add_f32 v[82:83], v[82:83], v[114:115]
    v_pk_add_f32 v[84:85], v[84:85], v[116:117]
    v_pk_add_f32 v[86:87], v[86:87], v[118:119]
    v_pk_add_f32 v[88:89], v[88:89], v[120:121]
    v_pk_add_f32 v[90:91], v[90:91], v[122:123]
    v_pk_add_f32 v[92:93], v[92:93], v[124:125]
    v_pk_add_f32 v[94:95], v[94:95], v[126:127]
    v_pk_add_f32 v[64:65], v[64:65], v[80:81]
    v_pk_add_f32 v[66:67], v[66:67], v[82:83]
    v_pk_add_f32 v[68:69], v[68:69], v[84:85]
    v_pk_add_f32 v[70:71], v[70:71], v[86:87]
    v_pk_add_f32 v[72:73], v[72:73], v[88:89]
    v_pk_add_f32 v[74:75], v[74:75], v[90:91]
    v_pk_add_f32 v[76:77], v[76:77], v[92:93]
    v_pk_add_f32 v[78:79], v[78:79], v[94:95]
    v_pk_add_f32 v[64:65], v[64:65], v[72:73]
    v_pk_add_f32 v[66:67], v[66:67], v[74:75]
    v_pk_add_f32 v[68:69], v[68:69], v[76:77]
    v_pk_add_f32 v[70:71], v[70:71], v[78:79]
    v_cvt_pk_bf16_f32 v64, 0, v64
    v_cvt_pk_bf16_f32 v65, 0, v65
    v_cvt_pk_bf16_f32 v66, 0, v66
    v_cvt_pk_bf16_f32 v67, 0, v67
    v_cvt_pk_bf16_f32 v68, 0, v68
    v_cvt_pk_bf16_f32 v69, 0, v69
    v_cvt_pk_bf16_f32 v70, 0, v70
    v_cvt_pk_bf16_f32 v71, 0, v71
    v_pk_mul_f32 v[64:65], v[64:65], v[68:69]
    v_pk_mul_f32 v[66:67], v[66:67], v[70:71]
    v_cvt_pk_bf16_f32 v72, v64, v65
    v_cvt_pk_bf16_f32 v73, v66, v67
    ds_write_b64 v43, v[72:73] offset:20480
    s_waitcnt lgkmcnt(0)
    ds_read_b128 v[16:19], v44 offset:20480
    ds_read_b128 v[20:23], v44 offset:20496
    ds_read_b128 v[24:27], v44 offset:20512
    ds_read_b128 v[28:31], v44 offset:20528
    s_waitcnt lgkmcnt(0)
    s_barrier
    buffer_load_dwordx4 v[128:131], v32, s[60:63], s12 offen offset:0 nt
    buffer_load_dwordx4 v[132:135], v32, s[60:63], s12 offen offset:1280 nt
    buffer_load_dwordx4 v[136:139], v32, s[60:63], s12 offen offset:2560 nt
    s_add_u32 s12, s12, 3840
    buffer_load_dwordx4 v[140:143], v32, s[60:63], s12 offen offset:0 nt
    buffer_load_dwordx4 v[144:147], v32, s[60:63], s12 offen offset:1280 nt
    buffer_load_dwordx4 v[148:151], v32, s[60:63], s12 offen offset:2560 nt
    s_add_u32 s12, s12, 3840
    buffer_load_dwordx4 v[152:155], v32, s[60:63], s12 offen offset:0 nt
    buffer_load_dwordx4 v[156:159], v32, s[60:63], s12 offen offset:1280 nt
    buffer_load_dwordx4 v[160:163], v32, s[60:63], s12 offen offset:2560 nt
    s_add_u32 s12, s12, 3840
    buffer_load_dwordx4 v[164:167], v32, s[60:63], s12 offen offset:0 nt
    buffer_load_dwordx4 v[168:171], v32, s[60:63], s12 offen offset:1280 nt
    buffer_load_dwordx4 v[172:175], v32, s[60:63], s12 offen offset:2560 nt
    s_add_u32 s12, s12, 3840
    buffer_load_dwordx4 v[176:179], v32, s[60:63], s12 offen offset:0 nt
    buffer_load_dwordx4 v[180:183], v32, s[60:63], s12 offen offset:1280 nt
    buffer_load_dwordx4 v[184:187], v32, s[60:63], s12 offen offset:2560 nt
    s_add_u32 s12, s12, 3840
    buffer_load_dwordx4 v[188:191], v32, s[60:63], s12 offen offset:0 nt
    buffer_load_dwordx4 v[192:195], v32, s[60:63], s12 offen offset:1280 nt
    buffer_load_dwordx4 v[196:199], v32, s[60:63], s12 offen offset:2560 nt
    s_add_u32 s12, s12, 3840
    buffer_load_dwordx4 v[200:203], v32, s[60:63], s12 offen offset:0 nt
    buffer_load_dwordx4 v[204:207], v32, s[60:63], s12 offen offset:1280 nt
    buffer_load_dwordx4 v[208:211], v32, s[60:63], s12 offen offset:2560 nt
    s_add_u32 s12, s12, 3840
    buffer_load_dwordx4 v[212:215], v32, s[60:63], s12 offen offset:0 nt
    buffer_load_dwordx4 v[216:219], v32, s[60:63], s12 offen offset:1280 nt
    buffer_load_dwordx4 v[220:223], v32, s[60:63], s12 offen offset:2560 nt
    s_add_u32 s12, s12, 3840
    buffer_load_dwordx4 v[224:227], v32, s[60:63], s12 offen offset:0 nt
    buffer_load_dwordx4 v[228:231], v32, s[60:63], s12 offen offset:1280 nt
    buffer_load_dwordx4 v[232:235], v32, s[60:63], s12 offen offset:2560 nt
    s_add_u32 s12, s12, 3840
    buffer_load_dwordx4 v[236:239], v32, s[60:63], s12 offen offset:0 nt
    buffer_load_dwordx4 v[240:243], v32, s[60:63], s12 offen offset:1280 nt
    buffer_load_dwordx4 v[244:247], v32, s[60:63], s12 offen offset:2560 nt
    s_add_u32 s12, s12, 3840
    buffer_load_dwordx4 v[248:251], v32, s[60:63], s12 offen offset:0 nt
    buffer_load_dwordx4 v[252:255], v32, s[60:63], s12 offen offset:1280 nt
    v_perm_b32 v56, v16, v16, v48
    v_perm_b32 v57, v16, v16, v49
    v_perm_b32 v58, v16, v16, v50
    v_perm_b32 v59, v16, v16, v51
    s_waitcnt vmcnt(31)
    s_nop 0
    v_mfma_f32_16x16x32_bf16 v[8:11], v[56:59], v[128:131], 0
    v_perm_b32 v60, v16, v16, v52
    v_perm_b32 v61, v16, v16, v53
    v_perm_b32 v62, v16, v16, v54
    v_perm_b32 v63, v16, v16, v55
    s_waitcnt vmcnt(30)
    s_nop 0
    v_mfma_f32_16x16x32_bf16 v[8:11], v[60:63], v[132:135], v[8:11]
    v_perm_b32 v56, v17, v17, v48
    v_perm_b32 v57, v17, v17, v49
    v_perm_b32 v58, v17, v17, v50
    v_perm_b32 v59, v17, v17, v51
    s_waitcnt vmcnt(29)
    s_nop 0
    v_mfma_f32_16x16x32_bf16 v[8:11], v[56:59], v[136:139], v[8:11]
    v_perm_b32 v60, v17, v17, v52
    v_perm_b32 v61, v17, v17, v53
    v_perm_b32 v62, v17, v17, v54
    v_perm_b32 v63, v17, v17, v55
    s_waitcnt vmcnt(28)
    s_nop 0
    v_mfma_f32_16x16x32_bf16 v[8:11], v[60:63], v[140:143], v[8:11]
    v_perm_b32 v56, v18, v18, v48
    v_perm_b32 v57, v18, v18, v49
    v_perm_b32 v58, v18, v18, v50
    v_perm_b32 v59, v18, v18, v51
    s_waitcnt vmcnt(27)
    s_nop 0
    v_mfma_f32_16x16x32_bf16 v[8:11], v[56:59], v[144:147], v[8:11]
    v_perm_b32 v60, v18, v18, v52
    v_perm_b32 v61, v18, v18, v53
    v_perm_b32 v62, v18, v18, v54
    v_perm_b32 v63, v18, v18, v55
    s_waitcnt vmcnt(26)
    s_nop 0
    v_mfma_f32_16x16x32_bf16 v[8:11], v[60:63], v[148:151], v[8:11]
    v_perm_b32 v56, v19, v19, v48
    v_perm_b32 v57, v19, v19, v49
    v_perm_b32 v58, v19, v19, v50
    v_perm_b32 v59, v19, v19, v51
    s_waitcnt vmcnt(25)
    s_nop 0
    v_mfma_f32_16x16x32_bf16 v[8:11], v[56:59], v[152:155], v[8:11]
    v_perm_b32 v60, v19, v19, v52
    v_perm_b32 v61, v19, v19, v53
    v_perm_b32 v62, v19, v19, v54
    v_perm_b32 v63, v19, v19, v55
    s_waitcnt vmcnt(24)
    s_nop 0
    v_mfma_f32_16x16x32_bf16 v[8:11], v[60:63], v[156:159], v[8:11]
    v_perm_b32 v56, v20, v20, v48
    v_perm_b32 v57, v20, v20, v49
    v_perm_b32 v58, v20, v20, v50
    v_perm_b32 v59, v20, v20, v51
    s_waitcnt vmcnt(23)
    s_nop 0
    v_mfma_f32_16x16x32_bf16 v[8:11], v[56:59], v[160:163], v[8:11]
    v_perm_b32 v60, v20, v20, v52
    v_perm_b32 v61, v20, v20, v53
    v_perm_b32 v62, v20, v20, v54
    v_perm_b32 v63, v20, v20, v55
    s_waitcnt vmcnt(22)
    s_nop 0
    v_mfma_f32_16x16x32_bf16 v[8:11], v[60:63], v[164:167], v[8:11]
    v_perm_b32 v56, v21, v21, v48
    v_perm_b32 v57, v21, v21, v49
    v_perm_b32 v58, v21, v21, v50
    v_perm_b32 v59, v21, v21, v51
    s_waitcnt vmcnt(21)
    s_nop 0
    v_mfma_f32_16x16x32_bf16 v[8:11], v[56:59], v[168:171], v[8:11]
    v_perm_b32 v60, v21, v21, v52
    v_perm_b32 v61, v21, v21, v53
    v_perm_b32 v62, v21, v21, v54
    v_perm_b32 v63, v21, v21, v55
    s_waitcnt vmcnt(20)
    s_nop 0
    v_mfma_f32_16x16x32_bf16 v[8:11], v[60:63], v[172:175], v[8:11]
    v_perm_b32 v56, v22, v22, v48
    v_perm_b32 v57, v22, v22, v49
    v_perm_b32 v58, v22, v22, v50
    v_perm_b32 v59, v22, v22, v51
    s_waitcnt vmcnt(19)
    s_nop 0
    v_mfma_f32_16x16x32_bf16 v[8:11], v[56:59], v[176:179], v[8:11]
    v_perm_b32 v60, v22, v22, v52
    v_perm_b32 v61, v22, v22, v53
    v_perm_b32 v62, v22, v22, v54
    v_perm_b32 v63, v22, v22, v55
    s_waitcnt vmcnt(18)
    s_nop 0
    v_mfma_f32_16x16x32_bf16 v[8:11], v[60:63], v[180:183], v[8:11]
    v_perm_b32 v56, v23, v23, v48
    v_perm_b32 v57, v23, v23, v49
    v_perm_b32 v58, v23, v23, v50
    v_perm_b32 v59, v23, v23, v51
    s_waitcnt vmcnt(17)
    s_nop 0
    v_mfma_f32_16x16x32_bf16 v[8:11], v[56:59], v[184:187], v[8:11]
    v_perm_b32 v60, v23, v23, v52
    v_perm_b32 v61, v23, v23, v53
    v_perm_b32 v62, v23, v23, v54
    v_perm_b32 v63, v23, v23, v55
    s_waitcnt vmcnt(16)
    s_nop 0
    v_mfma_f32_16x16x32_bf16 v[8:11], v[60:63], v[188:191], v[8:11]
    v_perm_b32 v56, v24, v24, v48
    v_perm_b32 v57, v24, v24, v49
    v_perm_b32 v58, v24, v24, v50
    v_perm_b32 v59, v24, v24, v51
    s_waitcnt vmcnt(15)
    s_nop 0
    v_mfma_f32_16x16x32_bf16 v[8:11], v[56:59], v[192:195], v[8:11]
    v_perm_b32 v60, v24, v24, v52
    v_perm_b32 v61, v24, v24, v53
    v_perm_b32 v62, v24, v24, v54
    v_perm_b32 v63, v24, v24, v55
    s_waitcnt vmcnt(14)
    s_nop 0
    v_mfma_f32_16x16x32_bf16 v[8:11], v[60:63], v[196:199], v[8:11]
    v_perm_b32 v56, v25, v25, v48
    v_perm_b32 v57, v25, v25, v49
    v_perm_b32 v58, v25, v25, v50
    v_perm_b32 v59, v25, v25, v51
    s_waitcnt vmcnt(13)
    s_nop 0
    v_mfma_f32_16x16x32_bf16 v[8:11], v[56:59], v[200:203], v[8:11]
    v_perm_b32 v60, v25, v25, v52
    v_perm_b32 v61, v25, v25, v53
    v_perm_b32 v62, v25, v25, v54
    v_perm_b32 v63, v25, v25, v55
    s_waitcnt vmcnt(12)
    s_nop 0
    v_mfma_f32_16x16x32_bf16 v[8:11], v[60:63], v[204:207], v[8:11]
    v_perm_b32 v56, v26, v26, v48
    v_perm_b32 v57, v26, v26, v49
    v_perm_b32 v58, v26, v26, v50
    v_perm_b32 v59, v26, v26, v51
    s_waitcnt vmcnt(11)
    s_nop 0
    v_mfma_f32_16x16x32_bf16 v[8:11], v[56:59], v[208:211], v[8:11]
    v_perm_b32 v60, v26, v26, v52
    v_perm_b32 v61, v26, v26, v53
    v_perm_b32 v62, v26, v26, v54
    v_perm_b32 v63, v26, v26, v55
    s_waitcnt vmcnt(10)
    s_nop 0
    v_mfma_f32_16x16x32_bf16 v[8:11], v[60:63], v[212:215], v[8:11]
    v_perm_b32 v56, v27, v27, v48
    v_perm_b32 v57, v27, v27, v49
    v_perm_b32 v58, v27, v27, v50
    v_perm_b32 v59, v27, v27, v51
    s_waitcnt vmcnt(9)
    s_nop 0
    v_mfma_f32_16x16x32_bf16 v[8:11], v[56:59], v[216:219], v[8:11]
    v_perm_b32 v60, v27, v27, v52
    v_perm_b32 v61, v27, v27, v53
    v_perm_b32 v62, v27, v27, v54
    v_perm_b32 v63, v27, v27, v55
    s_waitcnt vmcnt(8)
    s_nop 0
    v_mfma_f32_16x16x32_bf16 v[8:11], v[60:63], v[220:223], v[8:11]
    v_perm_b32 v56, v28, v28, v48
    v_perm_b32 v57, v28, v28, v49
    v_perm_b32 v58, v28, v28, v50
    v_perm_b32 v59, v28, v28, v51
    s_waitcnt vmcnt(7)
    s_nop 0
    v_mfma_f32_16x16x32_bf16 v[8:11], v[56:59], v[224:227], v[8:11]
    v_perm_b32 v60, v28, v28, v52
    v_perm_b32 v61, v28, v28, v53
    v_perm_b32 v62, v28, v28, v54
    v_perm_b32 v63, v28, v28, v55
    s_waitcnt vmcnt(6)
    s_nop 0
    v_mfma_f32_16x16x32_bf16 v[8:11], v[60:63], v[228:231], v[8:11]
    v_perm_b32 v56, v29, v29, v48
    v_perm_b32 v57, v29, v29, v49
    v_perm_b32 v58, v29, v29, v50
    v_perm_b32 v59, v29, v29, v51
    s_waitcnt vmcnt(5)
    s_nop 0
    v_mfma_f32_16x16x32_bf16 v[8:11], v[56:59], v[232:235], v[8:11]
    v_perm_b32 v60, v29, v29, v52
    v_perm_b32 v61, v29, v29, v53
    v_perm_b32 v62, v29, v29, v54
    v_perm_b32 v63, v29, v29, v55
    s_waitcnt vmcnt(4)
    s_nop 0
    v_mfma_f32_16x16x32_bf16 v[8:11], v[60:63], v[236:239], v[8:11]
    v_perm_b32 v56, v30, v30, v48
    v_perm_b32 v57, v30, v30, v49
    v_perm_b32 v58, v30, v30, v50
    v_perm_b32 v59, v30, v30, v51
    s_waitcnt vmcnt(3)
    s_nop 0
    v_mfma_f32_16x16x32_bf16 v[8:11], v[56:59], v[240:243], v[8:11]
    v_perm_b32 v60, v30, v30, v52
    v_perm_b32 v61, v30, v30, v53
    v_perm_b32 v62, v30, v30, v54
    v_perm_b32 v63, v30, v30, v55
    s_waitcnt vmcnt(2)
    s_nop 0
    v_mfma_f32_16x16x32_bf16 v[8:11], v[60:63], v[244:247], v[8:11]
    v_perm_b32 v56, v31, v31, v48
    v_perm_b32 v57, v31, v31, v49
    v_perm_b32 v58, v31, v31, v50
    v_perm_b32 v59, v31, v31, v51
    s_waitcnt vmcnt(1)
    s_nop 0
    v_mfma_f32_16x16x32_bf16 v[8:11], v[56:59], v[248:251], v[8:11]
    v_perm_b32 v60, v31, v31, v52
    v_perm_b32 v61, v31, v31, v53
    v_perm_b32 v62, v31, v31, v54
    v_perm_b32 v63, v31, v31, v55
    s_waitcnt vmcnt(0)
    s_nop 0
    v_mfma_f32_16x16x32_bf16 v[8:11], v[60:63], v[252:255], v[8:11]
    s_nop 7
    v_min_u32 v8, -2, v8
    v_min_u32 v9, -2, v9
    v_min_u32 v10, -2, v10
    v_min_u32 v11, -2, v11
    buffer_store_dwordx4 v[8:11], v33, s[48:51], s75 offen sc1
L_adone:
L_end:
    s_endpgm
L_codeend:
.section .rodata,"a"
.p2align 6
.amdhsa_kernel recurrent_scan__gqa_block_cached__glu_gated_bilinear__decode_kernel
  .amdhsa_next_free_vgpr 256
  .amdhsa_next_free_sgpr 102
  .amdhsa_accum_offset 256
  .amdhsa_group_segment_fixed_size 0
  .amdhsa_kernarg_size 96
  .amdhsa_user_sgpr_count 2
  .amdhsa_user_sgpr_kernarg_segment_ptr 1
  .amdhsa_system_sgpr_workgroup_id_x 1
  .amdhsa_float_denorm_mode_32 3
.end_amdhsa_kernel
```
